```python
import torch

def _softmax(x, axis=-1):
    return torch.softmax(x, dim=axis)
def _gelu(x):
    return torch.nn.functional.gelu(x, approximate="tanh")
def _silu(x):
    return torch.nn.functional.silu(x)
def _sigmoid(x):
    return torch.sigmoid(x)
def _layernorm(x, axis=-1, eps=1e-5):
    m = x.mean(dim=axis, keepdim=True)
    v = x.var(dim=axis, keepdim=True, unbiased=False)
    return (x - m) / torch.sqrt(v + eps)
def _scatter_add(tgt, idx, src, axis=0):
    return tgt.clone().index_add_(axis, idx, src)
def _segment_sum(src, seg, n):
    out = torch.zeros((n,) + src.shape[1:], dtype=src.dtype)
    return out.index_add_(0, seg, src)
def _pad(x, pw):
    flat = tuple(v for pair in reversed(pw) for v in pair)
    return torch.nn.functional.pad(x, flat)

kernel_name = 'standalone__qk_norm__prompt'

def setup_inputs():

    _w = (lambda a: (lambda t: t.to(torch.bfloat16) if t.is_floating_point() else t)(torch.as_tensor(a)))
    B, H, S, D = 1, 16, 4096, 448
    Dh = D // H
    return {
        "q": _w((lambda *s: torch.randn(*s, dtype=torch.bfloat16) * 0.05)(B, H, S, Dh)),
        "k": _w((lambda *s: torch.randn(*s, dtype=torch.bfloat16) * 0.05)(B, H, S, Dh)),
        "v": _w((lambda *s: torch.randn(*s, dtype=torch.bfloat16) * 0.8)(B, H, S, Dh)),
        "t": _w(torch.abs((lambda *s: torch.randn(*s, dtype=torch.bfloat16) * 0.8)(H)) + 1.0),
    }

def reference(q, k, v, t):
    eps = 1e-6
    qn = q / (torch.sqrt((q * q).sum(axis=-1, keepdims=True)) + eps)
    kn = k / (torch.sqrt((k * k).sum(axis=-1, keepdims=True)) + eps)
    logits = torch.einsum('bhqd,bhkd->bhqk', qn, kn) * t[None, :, None, None]
    attn = _softmax(logits, axis=-1)
    return torch.einsum('bhqk,bhkd->bhqd', attn, v)
```

```asm
; @launch grid=(256,1,1) block=(512,1,1) lds=162048
.amdgcn_target "amdgcn-amd-amdhsa--gfx950"
.text
.globl standalone__qk_norm__prompt_kernel
.p2align 8
.type standalone__qk_norm__prompt_kernel,@function
standalone__qk_norm__prompt_kernel:
    s_cmp_ge_u32 s2, 256
    s_cbranch_scc1 L_end
    s_mov_b32 s57, 0
L_start:
    s_load_dwordx8 s[4:11], s[0:1], 0
    s_load_dwordx4 s[12:15], s[0:1], 32
    s_load_dwordx2 s[54:55], s[0:1], 48
    v_lshrrev_b32 v11, 6, v0
    v_and_b32 v1, 63, v0
    s_and_b32 s44, s2, 7
    v_readfirstlane_b32 s38, v11
    s_lshl_b32 s44, s44, 1
    s_bfe_u32 s45, s2, 0x10003
    s_add_u32 s36, s44, s45
    s_lshr_b32 s37, s2, 4
    s_cmp_ge_u32 s2, 64
    s_cbranch_scc1 L_nopf
    s_cmp_eq_u32 s38, 7
    s_cbranch_scc0 L_nopf
    s_getpc_b64 s[32:33]
L_pc:
    v_lshlrev_b32 v11, 7, v1
    v_mov_b32 v209, s33
    v_add_co_u32 v208, vcc, s32, v11
    v_add_u32 v11, 0x2000, v11
    v_min_u32 v11, L_raw-L_pc, v11
    v_addc_co_u32 v209, vcc, 0, v209, vcc
    v_mov_b32 v211, s33
    v_add_co_u32 v210, vcc, s32, v11
    global_load_dword v112, v[208:209], off
    s_nop 0
    v_addc_co_u32 v211, vcc, 0, v211, vcc
    global_load_dword v112, v[210:211], off
L_nopf:
    s_mul_i32 s44, s36, 229376
    s_mul_i32 s46, s37, 14336
    s_add_u32 s45, s46, s44
    s_lshr_b32 s43, s38, 2
    s_mul_i32 s42, s38, 3584
    v_lshlrev_b32 v5, 4, v1
    v_add_u32 v3, s42, v5
    s_add_u32 s42, s42, 32768
    s_lshl_b32 s48, s38, 12
    s_mov_b32 s18, 229376
    s_mov_b32 s19, 0x20000
    s_mov_b32 s30, 14336
    s_mov_b32 s31, 0x20000
    s_add_u32 s51, s48, 145408
    s_lshr_b32 s46, s36, 1
    s_lshl_b32 s46, s46, 2
    v_mov_b32 v207, 0x3f80
    s_mov_b32 s3, 0x3fa80000
    s_mov_b32 vcc_lo, 0xaaaaaaaa
    s_mov_b32 vcc_hi, 0xaaaaaaaa
    v_cndmask_b32 v12, v207, 1.0, vcc
    s_mov_b32 vcc_lo, 0x3
    s_mov_b32 vcc_hi, 0x30
    v_cndmask_b32 v240, 0, v12, vcc
    s_mov_b32 vcc_lo, 0xc
    s_mov_b32 vcc_hi, 0xc0
    v_cndmask_b32 v241, 0, v12, vcc
    s_mov_b32 vcc_lo, 0x300
    s_mov_b32 vcc_hi, 0x3000
    v_cndmask_b32 v242, 0, v12, vcc
    s_mov_b32 vcc_lo, 0xc00
    s_mov_b32 vcc_hi, 0xc000
    v_cndmask_b32 v243, 0, v12, vcc
    s_mov_b32 vcc_lo, 0x30000
    s_mov_b32 vcc_hi, 0x300000
    v_cndmask_b32 v244, 0, v12, vcc
    s_mov_b32 vcc_lo, 0xc0000
    s_mov_b32 vcc_hi, 0xc00000
    v_cndmask_b32 v245, 0, v12, vcc
    s_mov_b32 vcc_lo, 0x3000000
    s_mov_b32 vcc_hi, 0x30000000
    v_cndmask_b32 v246, 0, v12, vcc
    s_mov_b32 vcc_lo, 0xc000000
    s_mov_b32 vcc_hi, 0xc0000000
    v_cndmask_b32 v247, 0, v12, vcc
    v_mov_b32 v206, 0
    v_lshrrev_b32 v11, 5, v0
    v_mul_u32_u24 v11, 1536, v11
    v_lshl_add_u32 v4, v0, 4, v11
    s_waitcnt lgkmcnt(0)
    s_add_u32 s16, s6, s44
    s_addc_u32 s17, s7, 0
    s_mov_b32 m0, s48
    s_nop 0
    buffer_load_dwordx4 v3, s[16:19], 0 offen offset:0 lds
    buffer_load_dwordx4 v3, s[16:19], 0 offen offset:1024 lds
    buffer_load_dwordx4 v3, s[16:19], 0 offen offset:2048 lds
    buffer_load_dwordx4 v3, s[16:19], 0 offen offset:3072 lds
    s_cmp_eq_u32 s43, 0
    s_cbranch_scc0 L_noq
    s_add_u32 s28, s4, s45
    s_addc_u32 s29, s5, 0
    s_mov_b32 m0, s51
    s_nop 0
    buffer_load_dwordx4 v3, s[28:31], 0 offen offset:0 lds
    buffer_load_dwordx4 v3, s[28:31], 0 offen offset:1024 lds
    buffer_load_dwordx4 v3, s[28:31], 0 offen offset:2048 lds
    buffer_load_dwordx4 v3, s[28:31], 0 offen offset:3072 lds
L_noq:
    s_add_u32 s20, s8, s44
    s_addc_u32 s21, s9, 0
    s_mov_b32 s22, 229376
    s_mov_b32 s23, 0x20000
    s_cmp_eq_u32 s38, 4
    s_cbranch_scc0 L_notouch
    s_mul_i32 s56, s37, 1792
    v_lshlrev_b32 v11, 7, v1
    s_mov_b64 exec, 0x3fff
    buffer_load_dword v112, v11, s[20:23], s56 offen
    s_mov_b64 exec, -1
L_notouch:
    s_load_dword s39, s[10:11], s46
    s_add_u32 s24, s12, s45
    s_addc_u32 s25, s13, 0
    s_mov_b32 s26, 14336
    s_mov_b32 s27, 0x20000
    s_mov_b32 s32, s14
    s_mov_b32 s33, s15
    s_mov_b32 s34, 256
    s_mov_b32 s35, 0x20000
    s_mul_i32 s44, s36, 262144
    s_add_u32 s28, s54, s44
    s_addc_u32 s29, s55, 0
    s_mov_b32 s30, 262144
    v_mov_b64 v[188:189], 0
    v_mov_b64 v[190:191], 0
    s_and_b32 s52, s37, 1
    s_cmp_eq_u32 s52, s43
    s_cselect_b32 s52, 1, 0
    s_cmp_ge_u32 s37, 2
    s_cselect_b32 s52, s52, 0
    v_mfma_f32_32x32x16_bf16 v[48:63], v[188:191], v[188:191], 0
    s_lshr_b32 s49, s37, 1
    s_max_u32 s49, s49, 1
    s_mul_i32 s41, s49, 28672
    s_lshl_b32 s49, s49, 15
    s_lshr_b32 s45, s38, 1
    s_lshl_b32 s44, s45, 13
    v_add_u32 v5, s44, v5
    v_mfma_f32_32x32x16_bf16 v[80:95], v[188:191], v[188:191], 0
    s_mul_i32 s44, s45, 7168
    s_add_u32 s44, s44, 32768
    v_and_b32 v11, 15, v0
    v_bfe_u32 v12, v0, 2, 2
    v_mad_u32_u24 v11, v12, 3, v11
    v_lshrrev_b32 v12, 4, v1
    v_lshl_add_u32 v11, v12, 2, v11
    v_lshrrev_b32 v12, 5, v1
    v_mad_u32_u24 v11, v12, 48, v11
    v_mfma_f32_32x32x16_bf16 v[64:79], v[188:191], v[188:191], 0
    v_lshl_add_u32 v6, v11, 3, s44
    v_mov_b32 v7, 65536
    v_lshlrev_b32 v12, 6, v12
    v_sub_u32 v12, 131296, v12
    s_mov_b32 vcc_lo, 0x88880000
    s_mov_b32 vcc_hi, 0x88880000
    v_cndmask_b32 v6, v6, v12, vcc
    v_cndmask_b32 v7, v7, v206, vcc
    v_mfma_f32_32x32x16_bf16 v[96:111], v[188:191], v[188:191], 0
    v_mov_b32 v8, 0xdddddddd
    v_mfma_f32_32x32x16_bf16 v[144:159], v[188:191], v[188:191], 0
    v_mfma_f32_32x32x16_bf16 v[160:175], v[188:191], v[188:191], 0
    s_cmp_eq_u32 s43, 0
    s_cbranch_scc1 L_two
    v_subrev_u32 v9, 14336, v3
    s_sub_u32 s51, s42, 14336
    s_cmp_eq_u32 s38, 6
    s_cbranch_scc0 L_noones
    v_lshrrev_b32 v11, 3, v1
    v_mul_u32_u24 v11, 1792, v11
    v_bfe_u32 v12, v0, 2, 1
    v_mul_u32_u24 v12, 896, v12
    v_add_u32 v11, v11, v12
    v_bfe_u32 v12, v0, 1, 1
    v_mul_u32_u24 v12, 224, v12
    v_add_u32 v11, v11, v12
    v_and_b32 v12, 1, v0
    v_lshl_add_u32 v11, v12, 6, v11
    v_add_u32 v11, 131232, v11
    v_mov_b32 v12, 161792
    v_mov_b32 v208, 0x3f80
    v_mov_b32 v209, 0
    ds_write_b64 v11, v[208:209]
    ds_write_b64 v12, v[188:189]
L_noones:
    v_mad_u32_u24 v11, v1, 56, s48
    s_waitcnt vmcnt(1)
    s_cmp_eq_u32 s38, 4
    s_cbranch_scc1 L_kready
    s_waitcnt vmcnt(0)
L_kready:
    ds_read2_b64 v[192:195], v11 offset0:0 offset1:1
    ds_read2_b64 v[196:199], v11 offset0:2 offset1:3
    ds_read2_b64 v[200:203], v11 offset0:4 offset1:5
    ds_read_b64 v[204:205], v11 offset:48
    s_mov_b32 m0, s51
    s_nop 0
    buffer_load_dwordx4 v9, s[20:23], 0 offen offset:0 lds
    buffer_load_dwordx4 v9, s[20:23], 0 offen offset:1024 lds
    buffer_load_dwordx4 v9, s[20:23], 0 offen offset:2048 lds
    buffer_load_dwordx4 v9, s[20:23], 0 offen offset:3072 lds
    s_mov_b32 m0, s42
    s_nop 0
    buffer_load_dwordx4 v3, s[20:23], 0 offen offset:0 lds
    buffer_load_dwordx4 v3, s[20:23], 0 offen offset:1024 lds
    buffer_load_dwordx4 v3, s[20:23], 0 offen offset:2048 lds
    buffer_load_dwordx4 v3, s[20:23], 0 offen offset:3072 lds
    s_waitcnt lgkmcnt(0)
    s_bitcmp1_b32 s36, 0
    s_cselect_b32 s44, 0, 16
    s_lshl_b32 s39, s39, s44
    s_and_b32 s39, s39, 0xffff0000
    s_and_b32 s44, s39, 0x7fffffff
    s_cmp_gt_u32 s44, 0x41800000
    s_cselect_b32 s53, 1, s57
    v_mfma_f32_32x32x16_bf16 v[208:223], v[240:243], v[192:195], 0
    v_mfma_f32_32x32x16_bf16 v[208:223], v[244:247], v[196:199], v[208:223]
    v_mfma_f32_32x32x16_bf16 v[224:239], v[240:243], v[200:203], 0
    v_mfma_f32_32x32x16_bf16 v[224:239], v[244:247], v[204:207], v[224:239]
    s_nop 9
    v_pk_mul_f32 v[12:13], v[208:209], v[208:209]
    v_pk_fma_f32 v[12:13], v[210:211], v[210:211], v[12:13]
    v_pk_fma_f32 v[12:13], v[212:213], v[212:213], v[12:13]
    v_pk_fma_f32 v[12:13], v[214:215], v[214:215], v[12:13]
    v_pk_fma_f32 v[12:13], v[216:217], v[216:217], v[12:13]
    v_pk_fma_f32 v[12:13], v[218:219], v[218:219], v[12:13]
    v_pk_fma_f32 v[12:13], v[220:221], v[220:221], v[12:13]
    v_pk_fma_f32 v[12:13], v[222:223], v[222:223], v[12:13]
    v_pk_fma_f32 v[12:13], v[224:225], v[224:225], v[12:13]
    v_pk_fma_f32 v[12:13], v[226:227], v[226:227], v[12:13]
    v_pk_fma_f32 v[12:13], v[228:229], v[228:229], v[12:13]
    v_pk_fma_f32 v[12:13], v[230:231], v[230:231], v[12:13]
    v_pk_fma_f32 v[12:13], v[232:233], v[232:233], v[12:13]
    v_pk_fma_f32 v[12:13], v[234:235], v[234:235], v[12:13]
    v_add_f32 v10, v12, v13
    v_sqrt_f32 v10, v10
    s_nop 0
    v_add_f32 v10, 0x358637bd, v10
    v_rcp_f32 v10, v10
    s_nop 0
    v_pk_mul_f32 v[208:209], v[208:209], v[10:11] op_sel_hi:[1,0]
    v_pk_mul_f32 v[210:211], v[210:211], v[10:11] op_sel_hi:[1,0]
    v_cvt_pk_bf16_f32 v192, v208, v209
    v_pk_mul_f32 v[212:213], v[212:213], v[10:11] op_sel_hi:[1,0]
    v_cvt_pk_bf16_f32 v193, v210, v211
    v_pk_mul_f32 v[214:215], v[214:215], v[10:11] op_sel_hi:[1,0]
    v_cvt_pk_bf16_f32 v194, v212, v213
    v_pk_mul_f32 v[216:217], v[216:217], v[10:11] op_sel_hi:[1,0]
    v_cvt_pk_bf16_f32 v195, v214, 1.0
    v_pk_mul_f32 v[218:219], v[218:219], v[10:11] op_sel_hi:[1,0]
    v_cvt_pk_bf16_f32 v196, v215, v216
    v_pk_mul_f32 v[220:221], v[220:221], v[10:11] op_sel_hi:[1,0]
    ds_write_b128 v4, v[192:195] offset:0
    v_cvt_pk_bf16_f32 v197, v217, v218
    v_pk_mul_f32 v[222:223], v[222:223], v[10:11] op_sel_hi:[1,0]
    v_cvt_pk_bf16_f32 v198, v219, v220
    v_cvt_pk_bf16_f32 v199, v221, s3
    v_pk_mul_f32 v[224:225], v[224:225], v[10:11] op_sel_hi:[1,0]
    v_cvt_pk_bf16_f32 v200, v222, v223
    v_pk_mul_f32 v[226:227], v[226:227], v[10:11] op_sel_hi:[1,0]
    ds_write_b128 v4, v[196:199] offset:512
    v_cvt_pk_bf16_f32 v201, v224, v225
    v_pk_mul_f32 v[228:229], v[228:229], v[10:11] op_sel_hi:[1,0]
    v_cvt_pk_bf16_f32 v202, v226, v227
    v_pk_mul_f32 v[230:231], v[230:231], v[10:11] op_sel_hi:[1,0]
    v_cvt_pk_bf16_f32 v203, v228, 1.0
    v_pk_mul_f32 v[232:233], v[232:233], v[10:11] op_sel_hi:[1,0]
    v_cvt_pk_bf16_f32 v204, v229, v230
    v_pk_mul_f32 v[234:235], v[234:235], v[10:11] op_sel_hi:[1,0]
    ds_write_b128 v4, v[200:203] offset:1024
    v_cvt_pk_bf16_f32 v205, v231, v232
    v_cvt_pk_bf16_f32 v206, v233, v234
    v_cvt_pk_bf16_f32 v207, v235, 1.0
    ds_write_b128 v4, v[204:207] offset:1536
    s_waitcnt vmcnt(0)
    s_branch L_join
L_two:
    v_mov_b64 v[30:31], 0
    v_mad_u32_u24 v11, v1, 56, s48
    v_add_u32 v9, 145408, v11
    v_add_u32 v14, 145408, v4
    s_waitcnt vmcnt(4)
    ds_read2_b64 v[192:195], v11 offset0:0 offset1:1
    ds_read2_b64 v[196:199], v11 offset0:2 offset1:3
    ds_read2_b64 v[200:203], v11 offset0:4 offset1:5
    ds_read_b64 v[204:205], v11 offset:48
    s_waitcnt lgkmcnt(0)
    v_mfma_f32_32x32x16_bf16 v[208:223], v[240:243], v[192:195], 0
    v_mfma_f32_32x32x16_bf16 v[208:223], v[244:247], v[196:199], v[208:223]
    v_mfma_f32_32x32x16_bf16 v[224:239], v[240:243], v[200:203], 0
    v_mfma_f32_32x32x16_bf16 v[224:239], v[244:247], v[204:207], v[224:239]
    s_bitcmp1_b32 s36, 0
    s_cselect_b32 s44, 0, 16
    s_lshl_b32 s39, s39, s44
    s_and_b32 s39, s39, 0xffff0000
    s_and_b32 s44, s39, 0x7fffffff
    s_cmp_gt_u32 s44, 0x41800000
    s_cselect_b32 s53, 1, s57
    s_cmp_eq_u32 s53, 1
    s_cselect_b32 s46, 0, 0xc4c00000
    s_cselect_b32 s78, 0, 0xc4970000
    s_cselect_b32 s79, 0, 0x44c00000
    s_cselect_b64 vcc, -1, 0
    v_mov_b32 v15, 0x3fb8aa3b
    v_mul_f32 v15, s39, v15
    v_cndmask_b32 v15, v15, 1.0, vcc
    s_nop 3
    v_pk_mul_f32 v[12:13], v[208:209], v[208:209]
    v_pk_fma_f32 v[12:13], v[210:211], v[210:211], v[12:13]
    v_pk_fma_f32 v[12:13], v[212:213], v[212:213], v[12:13]
    v_pk_fma_f32 v[12:13], v[214:215], v[214:215], v[12:13]
    v_pk_fma_f32 v[12:13], v[216:217], v[216:217], v[12:13]
    v_pk_fma_f32 v[12:13], v[218:219], v[218:219], v[12:13]
    v_pk_fma_f32 v[12:13], v[220:221], v[220:221], v[12:13]
    v_pk_fma_f32 v[12:13], v[222:223], v[222:223], v[12:13]
    v_pk_fma_f32 v[12:13], v[224:225], v[224:225], v[12:13]
    v_pk_fma_f32 v[12:13], v[226:227], v[226:227], v[12:13]
    v_pk_fma_f32 v[12:13], v[228:229], v[228:229], v[12:13]
    v_pk_fma_f32 v[12:13], v[230:231], v[230:231], v[12:13]
    v_pk_fma_f32 v[12:13], v[232:233], v[232:233], v[12:13]
    v_pk_fma_f32 v[12:13], v[234:235], v[234:235], v[12:13]
    v_add_f32 v10, v12, v13
    v_sqrt_f32 v10, v10
    s_nop 0
    v_add_f32 v10, 0x358637bd, v10
    v_rcp_f32 v10, v10
    s_nop 0
    v_pk_mul_f32 v[208:209], v[208:209], v[10:11] op_sel_hi:[1,0]
    v_pk_mul_f32 v[210:211], v[210:211], v[10:11] op_sel_hi:[1,0]
    v_cvt_pk_bf16_f32 v192, v208, v209
    v_pk_mul_f32 v[212:213], v[212:213], v[10:11] op_sel_hi:[1,0]
    v_cvt_pk_bf16_f32 v193, v210, v211
    v_pk_mul_f32 v[214:215], v[214:215], v[10:11] op_sel_hi:[1,0]
    v_cvt_pk_bf16_f32 v194, v212, v213
    v_pk_mul_f32 v[216:217], v[216:217], v[10:11] op_sel_hi:[1,0]
    v_cvt_pk_bf16_f32 v195, v214, 1.0
    v_pk_mul_f32 v[218:219], v[218:219], v[10:11] op_sel_hi:[1,0]
    v_cvt_pk_bf16_f32 v196, v215, v216
    v_pk_mul_f32 v[220:221], v[220:221], v[10:11] op_sel_hi:[1,0]
    ds_write_b128 v4, v[192:195] offset:0
    v_cvt_pk_bf16_f32 v197, v217, v218
    v_pk_mul_f32 v[222:223], v[222:223], v[10:11] op_sel_hi:[1,0]
    v_cvt_pk_bf16_f32 v198, v219, v220
    v_cvt_pk_bf16_f32 v199, v221, s3
    v_pk_mul_f32 v[224:225], v[224:225], v[10:11] op_sel_hi:[1,0]
    v_cvt_pk_bf16_f32 v200, v222, v223
    v_pk_mul_f32 v[226:227], v[226:227], v[10:11] op_sel_hi:[1,0]
    ds_write_b128 v4, v[196:199] offset:512
    v_cvt_pk_bf16_f32 v201, v224, v225
    v_pk_mul_f32 v[228:229], v[228:229], v[10:11] op_sel_hi:[1,0]
    v_cvt_pk_bf16_f32 v202, v226, v227
    v_pk_mul_f32 v[230:231], v[230:231], v[10:11] op_sel_hi:[1,0]
    v_cvt_pk_bf16_f32 v203, v228, 1.0
    v_pk_mul_f32 v[232:233], v[232:233], v[10:11] op_sel_hi:[1,0]
    v_cvt_pk_bf16_f32 v204, v229, v230
    v_pk_mul_f32 v[234:235], v[234:235], v[10:11] op_sel_hi:[1,0]
    ds_write_b128 v4, v[200:203] offset:1024
    v_cvt_pk_bf16_f32 v205, v231, v232
    v_cvt_pk_bf16_f32 v206, v233, v234
    v_cvt_pk_bf16_f32 v207, v235, 1.0
    ds_write_b128 v4, v[204:207] offset:1536
    s_waitcnt vmcnt(0)
    ds_read2_b64 v[16:19], v9 offset0:0 offset1:1
    ds_read2_b64 v[20:23], v9 offset0:2 offset1:3
    ds_read2_b64 v[24:27], v9 offset0:4 offset1:5
    ds_read_b64 v[28:29], v9 offset:48
    s_waitcnt lgkmcnt(0)
    v_mfma_f32_32x32x16_bf16 v[208:223], v[240:243], v[16:19], 0
    v_mfma_f32_32x32x16_bf16 v[208:223], v[244:247], v[20:23], v[208:223]
    v_mfma_f32_32x32x16_bf16 v[224:239], v[240:243], v[24:27], 0
    v_mfma_f32_32x32x16_bf16 v[224:239], v[244:247], v[28:31], v[224:239]
    s_nop 9
    v_pk_mul_f32 v[12:13], v[208:209], v[208:209]
    v_pk_fma_f32 v[12:13], v[210:211], v[210:211], v[12:13]
    v_pk_fma_f32 v[12:13], v[212:213], v[212:213], v[12:13]
    v_pk_fma_f32 v[12:13], v[214:215], v[214:215], v[12:13]
    v_pk_fma_f32 v[12:13], v[216:217], v[216:217], v[12:13]
    v_pk_fma_f32 v[12:13], v[218:219], v[218:219], v[12:13]
    v_pk_fma_f32 v[12:13], v[220:221], v[220:221], v[12:13]
    v_pk_fma_f32 v[12:13], v[222:223], v[222:223], v[12:13]
    v_pk_fma_f32 v[12:13], v[224:225], v[224:225], v[12:13]
    v_pk_fma_f32 v[12:13], v[226:227], v[226:227], v[12:13]
    v_pk_fma_f32 v[12:13], v[228:229], v[228:229], v[12:13]
    v_pk_fma_f32 v[12:13], v[230:231], v[230:231], v[12:13]
    v_pk_fma_f32 v[12:13], v[232:233], v[232:233], v[12:13]
    v_pk_fma_f32 v[12:13], v[234:235], v[234:235], v[12:13]
    v_add_f32 v10, v12, v13
    v_sqrt_f32 v10, v10
    s_nop 0
    v_add_f32 v10, 0x358637bd, v10
    v_rcp_f32 v10, v10
    s_nop 0
    v_mul_f32 v10, v15, v10
    v_pk_mul_f32 v[208:209], v[208:209], v[10:11] op_sel_hi:[1,0]
    v_pk_mul_f32 v[210:211], v[210:211], v[10:11] op_sel_hi:[1,0]
    v_cvt_pk_bf16_f32 v16, v208, v209
    v_pk_mul_f32 v[212:213], v[212:213], v[10:11] op_sel_hi:[1,0]
    v_cvt_pk_bf16_f32 v17, v210, v211
    v_pk_mul_f32 v[214:215], v[214:215], v[10:11] op_sel_hi:[1,0]
    v_cvt_pk_bf16_f32 v18, v212, v213
    v_pk_mul_f32 v[216:217], v[216:217], v[10:11] op_sel_hi:[1,0]
    v_cvt_pk_bf16_f32 v19, v214, s46
    v_pk_mul_f32 v[218:219], v[218:219], v[10:11] op_sel_hi:[1,0]
    v_cvt_pk_bf16_f32 v20, v215, v216
    v_pk_mul_f32 v[220:221], v[220:221], v[10:11] op_sel_hi:[1,0]
    ds_write_b128 v14, v[16:19] offset:0
    v_cvt_pk_bf16_f32 v21, v217, v218
    v_pk_mul_f32 v[222:223], v[222:223], v[10:11] op_sel_hi:[1,0]
    v_cvt_pk_bf16_f32 v22, v219, v220
    v_cvt_pk_bf16_f32 v23, v221, s78
    v_pk_mul_f32 v[224:225], v[224:225], v[10:11] op_sel_hi:[1,0]
    v_cvt_pk_bf16_f32 v24, v222, v223
    v_pk_mul_f32 v[226:227], v[226:227], v[10:11] op_sel_hi:[1,0]
    ds_write_b128 v14, v[20:23] offset:512
    v_cvt_pk_bf16_f32 v25, v224, v225
    v_pk_mul_f32 v[228:229], v[228:229], v[10:11] op_sel_hi:[1,0]
    v_cvt_pk_bf16_f32 v26, v226, v227
    v_pk_mul_f32 v[230:231], v[230:231], v[10:11] op_sel_hi:[1,0]
    v_cvt_pk_bf16_f32 v27, v228, s79
    v_pk_mul_f32 v[232:233], v[232:233], v[10:11] op_sel_hi:[1,0]
    v_cvt_pk_bf16_f32 v28, v229, v230
    v_pk_mul_f32 v[234:235], v[234:235], v[10:11] op_sel_hi:[1,0]
    ds_write_b128 v14, v[24:27] offset:1024
    v_cvt_pk_bf16_f32 v29, v231, v232
    v_cvt_pk_bf16_f32 v30, v233, v234
    v_cvt_pk_bf16_f32 v31, v235, s79
    ds_write_b128 v14, v[28:31] offset:1536
L_join:
    s_mov_b32 s47, 65536
    v_lshl_add_u32 v2, v1, 4, s48
    s_and_b32 s44, s38, 1
    s_lshl_b32 s44, s44, 13
    s_add_u32 s44, s44, 145408
    v_lshl_add_u32 v11, v1, 4, s44
    s_mov_b32 s51, 0
    s_mov_b32 s50, 0
    s_mov_b32 s40, 0
    s_waitcnt lgkmcnt(0)
    s_barrier
    ds_read_b128 v[176:179], v5 offset:0
    ds_read_b128 v[16:19], v11 offset:0
    ds_read_b128 v[180:183], v5 offset:1024
    ds_read_b128 v[20:23], v11 offset:1024
    ds_read_b128 v[24:27], v11 offset:2048
    ds_read_b128 v[28:31], v11 offset:3072
    ds_read_b128 v[32:35], v11 offset:4096
    ds_read_b128 v[40:43], v11 offset:6144
    ds_read_b128 v[36:39], v11 offset:5120
    ds_read_b128 v[44:47], v11 offset:7168
    s_cmp_eq_u32 s53, 1
    s_cbranch_scc1 L_slow
    ds_read_b64_tr_b16 v[184:185], v6 offset:0
    s_waitcnt lgkmcnt(9)
    v_mfma_f32_32x32x16_bf16 v[112:127], v[176:179], v[16:19], 0
    s_waitcnt lgkmcnt(7)
    v_mfma_f32_32x32x16_bf16 v[112:127], v[180:183], v[20:23], v[112:127]
    s_waitcnt lgkmcnt(5)
    v_mfma_f32_32x32x16_bf16 v[128:143], v[176:179], v[24:27], 0
    v_mfma_f32_32x32x16_bf16 v[128:143], v[180:183], v[28:31], v[128:143]
    s_nop 7
    s_setprio 3
    v_exp_f32 v112, v112
    v_exp_f32 v113, v113
    v_smfmac_f32_32x32x32_bf16 v[80:95], v[188:191], v[152:159], v8
    ds_read_b64_tr_b16 v[186:187], v6 offset:224
    s_xor_b32 m0, s48, s47
    v_exp_f32 v114, v114
    v_exp_f32 v115, v115
    v_exp_f32 v116, v116
    v_exp_f32 v117, v117
    v_smfmac_f32_32x32x32_bf16 v[96:111], v[188:191], v[168:175], v8
    ds_read_b64_tr_b16 v[188:189], v6 offset:896
    s_waitcnt lgkmcnt(3)
    v_exp_f32 v118, v118
    v_exp_f32 v119, v119
    v_exp_f32 v128, v128
    v_exp_f32 v129, v129
    v_mfma_f32_32x32x16_bf16 v[144:159], v[176:179], v[32:35], 0
    ds_read_b64_tr_b16 v[190:191], v6 offset:1120
    v_exp_f32 v130, v130
    v_exp_f32 v131, v131
    v_exp_f32 v132, v132
    v_exp_f32 v133, v133
    v_mfma_f32_32x32x16_bf16 v[160:175], v[176:179], v[40:43], 0
    ds_read_b128 v[176:179], v5 offset:2048
    v_exp_f32 v134, v134
    v_exp_f32 v135, v135
    v_exp_f32 v120, v120
    v_exp_f32 v121, v121
    v_mfma_f32_32x32x16_bf16 v[144:159], v[180:183], v[36:39], v[144:159]
    buffer_load_dwordx4 v3, s[16:19], s41 offen offset:0 lds
    v_exp_f32 v122, v122
    v_exp_f32 v123, v123
    v_exp_f32 v124, v124
    v_exp_f32 v125, v125
    v_mfma_f32_32x32x16_bf16 v[160:175], v[180:183], v[44:47], v[160:175]
    ds_read_b128 v[180:183], v5 offset:3072
    s_waitcnt lgkmcnt(2)
    v_exp_f32 v126, v126
    v_exp_f32 v127, v127
    v_exp_f32 v136, v136
    v_exp_f32 v137, v137
    v_smfmac_f32_32x32x32_bf16 v[48:63], v[184:187], v[112:119], v8
    buffer_load_dwordx4 v3, s[16:19], s41 offen offset:1024 lds
    v_exp_f32 v138, v138
    v_exp_f32 v139, v139
    v_exp_f32 v140, v140
    v_exp_f32 v141, v141
    v_smfmac_f32_32x32x32_bf16 v[64:79], v[184:187], v[128:135], v8
    v_exp_f32 v142, v142
    v_exp_f32 v143, v143
    v_exp_f32 v144, v144
    v_exp_f32 v145, v145
    v_smfmac_f32_32x32x32_bf16 v[48:63], v[188:191], v[120:127], v8
    v_exp_f32 v146, v146
    v_exp_f32 v147, v147
    v_exp_f32 v148, v148
    v_exp_f32 v149, v149
    v_smfmac_f32_32x32x32_bf16 v[64:79], v[188:191], v[136:143], v8
    s_waitcnt lgkmcnt(0)
    v_exp_f32 v150, v150
    v_exp_f32 v151, v151
    v_exp_f32 v160, v160
    v_exp_f32 v161, v161
    v_mfma_f32_32x32x16_bf16 v[112:127], v[176:179], v[16:19], 0
    v_exp_f32 v162, v162
    v_exp_f32 v163, v163
    v_exp_f32 v164, v164
    v_exp_f32 v165, v165
    v_mfma_f32_32x32x16_bf16 v[128:143], v[176:179], v[24:27], 0
    v_exp_f32 v166, v166
    v_exp_f32 v167, v167
    v_exp_f32 v152, v152
    v_exp_f32 v153, v153
    v_mfma_f32_32x32x16_bf16 v[112:127], v[180:183], v[20:23], v[112:127]
    buffer_load_dwordx4 v3, s[16:19], s41 offen offset:2048 lds
    v_exp_f32 v154, v154
    v_exp_f32 v155, v155
    v_exp_f32 v156, v156
    v_exp_f32 v157, v157
    v_mfma_f32_32x32x16_bf16 v[128:143], v[180:183], v[28:31], v[128:143]
    v_exp_f32 v158, v158
    v_exp_f32 v159, v159
    v_exp_f32 v168, v168
    v_exp_f32 v169, v169
    v_smfmac_f32_32x32x32_bf16 v[80:95], v[184:187], v[144:151], v8
    buffer_load_dwordx4 v3, s[16:19], s41 offen offset:3072 lds
    v_exp_f32 v170, v170
    v_exp_f32 v171, v171
    v_exp_f32 v172, v172
    v_exp_f32 v173, v173
    v_smfmac_f32_32x32x32_bf16 v[96:111], v[184:187], v[160:167], v8
    ds_read_b64_tr_b16 v[184:185], v6 offset:1792
    v_exp_f32 v174, v174
    v_exp_f32 v175, v175
    v_exp_f32 v112, v112
    v_exp_f32 v113, v113
    v_smfmac_f32_32x32x32_bf16 v[80:95], v[188:191], v[152:159], v8
    ds_read_b64_tr_b16 v[186:187], v6 offset:2016
    s_xor_b32 m0, s42, s47
    v_exp_f32 v114, v114
    v_exp_f32 v115, v115
    v_exp_f32 v116, v116
    v_exp_f32 v117, v117
    v_smfmac_f32_32x32x32_bf16 v[96:111], v[188:191], v[168:175], v8
    ds_read_b64_tr_b16 v[188:189], v6 offset:2688
    v_exp_f32 v118, v118
    v_exp_f32 v119, v119
    v_exp_f32 v128, v128
    v_exp_f32 v129, v129
    v_mfma_f32_32x32x16_bf16 v[144:159], v[176:179], v[32:35], 0
    ds_read_b64_tr_b16 v[190:191], v6 offset:2912
    v_exp_f32 v130, v130
    v_exp_f32 v131, v131
    v_exp_f32 v132, v132
    v_exp_f32 v133, v133
    v_mfma_f32_32x32x16_bf16 v[160:175], v[176:179], v[40:43], 0
    ds_read_b128 v[176:179], v5 offset:4096
    v_exp_f32 v134, v134
    v_exp_f32 v135, v135
    v_exp_f32 v120, v120
    v_exp_f32 v121, v121
    v_mfma_f32_32x32x16_bf16 v[144:159], v[180:183], v[36:39], v[144:159]
    buffer_load_dwordx4 v3, s[20:23], s41 offen offset:0 lds
    v_exp_f32 v122, v122
    v_exp_f32 v123, v123
    v_exp_f32 v124, v124
    v_exp_f32 v125, v125
    v_mfma_f32_32x32x16_bf16 v[160:175], v[180:183], v[44:47], v[160:175]
    ds_read_b128 v[180:183], v5 offset:5120
    s_waitcnt lgkmcnt(2)
    v_exp_f32 v126, v126
    v_exp_f32 v127, v127
    v_exp_f32 v136, v136
    v_exp_f32 v137, v137
    v_smfmac_f32_32x32x32_bf16 v[48:63], v[184:187], v[112:119], v8
    buffer_load_dwordx4 v3, s[20:23], s41 offen offset:1024 lds
    v_exp_f32 v138, v138
    v_exp_f32 v139, v139
    v_exp_f32 v140, v140
    v_exp_f32 v141, v141
    v_smfmac_f32_32x32x32_bf16 v[64:79], v[184:187], v[128:135], v8
    v_exp_f32 v142, v142
    v_exp_f32 v143, v143
    v_exp_f32 v144, v144
    v_exp_f32 v145, v145
    v_smfmac_f32_32x32x32_bf16 v[48:63], v[188:191], v[120:127], v8
    v_exp_f32 v146, v146
    v_exp_f32 v147, v147
    v_exp_f32 v148, v148
    v_exp_f32 v149, v149
    v_smfmac_f32_32x32x32_bf16 v[64:79], v[188:191], v[136:143], v8
    s_waitcnt lgkmcnt(0)
    v_exp_f32 v150, v150
    v_exp_f32 v151, v151
    v_exp_f32 v160, v160
    v_exp_f32 v161, v161
    v_mfma_f32_32x32x16_bf16 v[112:127], v[176:179], v[16:19], 0
    v_exp_f32 v162, v162
    v_exp_f32 v163, v163
    v_exp_f32 v164, v164
    v_exp_f32 v165, v165
    v_mfma_f32_32x32x16_bf16 v[128:143], v[176:179], v[24:27], 0
    v_exp_f32 v166, v166
    v_exp_f32 v167, v167
    v_exp_f32 v152, v152
    v_exp_f32 v153, v153
    v_mfma_f32_32x32x16_bf16 v[112:127], v[180:183], v[20:23], v[112:127]
    buffer_load_dwordx4 v3, s[20:23], s41 offen offset:2048 lds
    v_exp_f32 v154, v154
    v_exp_f32 v155, v155
    v_exp_f32 v156, v156
    v_exp_f32 v157, v157
    v_mfma_f32_32x32x16_bf16 v[128:143], v[180:183], v[28:31], v[128:143]
    v_exp_f32 v158, v158
    v_exp_f32 v159, v159
    v_exp_f32 v168, v168
    v_exp_f32 v169, v169
    v_smfmac_f32_32x32x32_bf16 v[80:95], v[184:187], v[144:151], v8
    buffer_load_dwordx4 v3, s[20:23], s41 offen offset:3072 lds
    v_exp_f32 v170, v170
    v_exp_f32 v171, v171
    v_exp_f32 v172, v172
    v_exp_f32 v173, v173
    v_smfmac_f32_32x32x32_bf16 v[96:111], v[184:187], v[160:167], v8
    ds_read_b64_tr_b16 v[184:185], v6 offset:3584
    v_exp_f32 v174, v174
    v_exp_f32 v175, v175
    v_exp_f32 v112, v112
    v_exp_f32 v113, v113
    v_smfmac_f32_32x32x32_bf16 v[80:95], v[188:191], v[152:159], v8
    ds_read_b64_tr_b16 v[186:187], v6 offset:3808
    s_setprio 2
    v_exp_f32 v114, v114
    v_exp_f32 v115, v115
    v_exp_f32 v116, v116
    v_exp_f32 v117, v117
    v_smfmac_f32_32x32x32_bf16 v[96:111], v[188:191], v[168:175], v8
    ds_read_b64_tr_b16 v[188:189], v6 offset:4480
    v_exp_f32 v118, v118
    v_exp_f32 v119, v119
    v_exp_f32 v128, v128
    v_exp_f32 v129, v129
    v_mfma_f32_32x32x16_bf16 v[144:159], v[176:179], v[32:35], 0
    ds_read_b64_tr_b16 v[190:191], v6 offset:4704
    v_exp_f32 v130, v130
    v_exp_f32 v131, v131
    v_exp_f32 v132, v132
    v_exp_f32 v133, v133
    v_mfma_f32_32x32x16_bf16 v[160:175], v[176:179], v[40:43], 0
    ds_read_b128 v[176:179], v5 offset:6144
    v_exp_f32 v134, v134
    v_exp_f32 v135, v135
    v_exp_f32 v120, v120
    v_exp_f32 v121, v121
    v_mfma_f32_32x32x16_bf16 v[144:159], v[180:183], v[36:39], v[144:159]
    v_exp_f32 v122, v122
    v_exp_f32 v123, v123
    v_exp_f32 v124, v124
    v_exp_f32 v125, v125
    v_mfma_f32_32x32x16_bf16 v[160:175], v[180:183], v[44:47], v[160:175]
    ds_read_b128 v[180:183], v5 offset:7168
    s_waitcnt lgkmcnt(2)
    v_exp_f32 v126, v126
    v_exp_f32 v127, v127
    v_exp_f32 v136, v136
    v_exp_f32 v137, v137
    v_smfmac_f32_32x32x32_bf16 v[48:63], v[184:187], v[112:119], v8
    v_exp_f32 v138, v138
    v_exp_f32 v139, v139
    v_exp_f32 v140, v140
    v_exp_f32 v141, v141
    v_smfmac_f32_32x32x32_bf16 v[64:79], v[184:187], v[128:135], v8
    v_exp_f32 v142, v142
    v_exp_f32 v143, v143
    s_waitcnt vmcnt(4)
    s_add_u32 s44, s48, s47
    v_mad_u32_u24 v11, v1, 56, s44
    v_add_u32 v9, s47, v4
    ds_read2_b64 v[192:195], v11 offset0:0 offset1:1
    ds_read2_b64 v[196:199], v11 offset0:2 offset1:3
    ds_read2_b64 v[200:203], v11 offset0:4 offset1:5
    ds_read_b64 v[204:205], v11 offset:48
    s_waitcnt lgkmcnt(0)
    v_mfma_f32_32x32x16_bf16 v[208:223], v[240:243], v[192:195], 0
    v_mfma_f32_32x32x16_bf16 v[208:223], v[244:247], v[196:199], v[208:223]
    v_mfma_f32_32x32x16_bf16 v[224:239], v[240:243], v[200:203], 0
    v_mfma_f32_32x32x16_bf16 v[224:239], v[244:247], v[204:207], v[224:239]
    s_nop 9
    v_pk_mul_f32 v[12:13], v[208:209], v[208:209]
    v_pk_fma_f32 v[12:13], v[210:211], v[210:211], v[12:13]
    v_pk_fma_f32 v[12:13], v[212:213], v[212:213], v[12:13]
    v_pk_fma_f32 v[12:13], v[214:215], v[214:215], v[12:13]
    v_pk_fma_f32 v[12:13], v[216:217], v[216:217], v[12:13]
    v_pk_fma_f32 v[12:13], v[218:219], v[218:219], v[12:13]
    v_pk_fma_f32 v[12:13], v[220:221], v[220:221], v[12:13]
    v_pk_fma_f32 v[12:13], v[222:223], v[222:223], v[12:13]
    v_pk_fma_f32 v[12:13], v[224:225], v[224:225], v[12:13]
    v_pk_fma_f32 v[12:13], v[226:227], v[226:227], v[12:13]
    v_pk_fma_f32 v[12:13], v[228:229], v[228:229], v[12:13]
    v_pk_fma_f32 v[12:13], v[230:231], v[230:231], v[12:13]
    v_pk_fma_f32 v[12:13], v[232:233], v[232:233], v[12:13]
    v_pk_fma_f32 v[12:13], v[234:235], v[234:235], v[12:13]
    v_add_f32 v10, v12, v13
    v_sqrt_f32 v10, v10
    s_nop 0
    v_add_f32 v10, 0x358637bd, v10
    v_rcp_f32 v10, v10
    s_nop 0
    v_pk_mul_f32 v[208:209], v[208:209], v[10:11] op_sel_hi:[1,0]
    v_pk_mul_f32 v[210:211], v[210:211], v[10:11] op_sel_hi:[1,0]
    v_cvt_pk_bf16_f32 v192, v208, v209
    v_pk_mul_f32 v[212:213], v[212:213], v[10:11] op_sel_hi:[1,0]
    v_cvt_pk_bf16_f32 v193, v210, v211
    v_pk_mul_f32 v[214:215], v[214:215], v[10:11] op_sel_hi:[1,0]
    v_cvt_pk_bf16_f32 v194, v212, v213
    v_pk_mul_f32 v[216:217], v[216:217], v[10:11] op_sel_hi:[1,0]
    v_cvt_pk_bf16_f32 v195, v214, 1.0
    v_pk_mul_f32 v[218:219], v[218:219], v[10:11] op_sel_hi:[1,0]
    v_cvt_pk_bf16_f32 v196, v215, v216
    v_pk_mul_f32 v[220:221], v[220:221], v[10:11] op_sel_hi:[1,0]
    ds_write_b128 v9, v[192:195] offset:0
    v_cvt_pk_bf16_f32 v197, v217, v218
    v_pk_mul_f32 v[222:223], v[222:223], v[10:11] op_sel_hi:[1,0]
    v_cvt_pk_bf16_f32 v198, v219, v220
    v_cvt_pk_bf16_f32 v199, v221, s3
    v_pk_mul_f32 v[224:225], v[224:225], v[10:11] op_sel_hi:[1,0]
    v_cvt_pk_bf16_f32 v200, v222, v223
    v_pk_mul_f32 v[226:227], v[226:227], v[10:11] op_sel_hi:[1,0]
    ds_write_b128 v9, v[196:199] offset:512
    v_cvt_pk_bf16_f32 v201, v224, v225
    v_pk_mul_f32 v[228:229], v[228:229], v[10:11] op_sel_hi:[1,0]
    v_cvt_pk_bf16_f32 v202, v226, v227
    v_pk_mul_f32 v[230:231], v[230:231], v[10:11] op_sel_hi:[1,0]
    v_cvt_pk_bf16_f32 v203, v228, 1.0
    v_pk_mul_f32 v[232:233], v[232:233], v[10:11] op_sel_hi:[1,0]
    v_cvt_pk_bf16_f32 v204, v229, v230
    v_pk_mul_f32 v[234:235], v[234:235], v[10:11] op_sel_hi:[1,0]
    ds_write_b128 v9, v[200:203] offset:1024
    v_cvt_pk_bf16_f32 v205, v231, v232
    v_cvt_pk_bf16_f32 v206, v233, v234
    v_cvt_pk_bf16_f32 v207, v235, 1.0
    ds_write_b128 v9, v[204:207] offset:1536
    s_cmp_eq_u32 s52, 1
    s_cbranch_scc0 L_published
    buffer_store_dwordx4 v[192:195], v4, s[28:31], s49 offen offset:0 sc1
    buffer_store_dwordx4 v[196:199], v4, s[28:31], s49 offen offset:512 sc1
    buffer_store_dwordx4 v[200:203], v4, s[28:31], s49 offen offset:1024 sc1
    buffer_store_dwordx4 v[204:207], v4, s[28:31], s49 offen offset:1536 sc1
L_published:
    v_exp_f32 v144, v144
    v_exp_f32 v145, v145
    v_smfmac_f32_32x32x32_bf16 v[48:63], v[188:191], v[120:127], v8
    s_setprio 1
    v_exp_f32 v146, v146
    v_exp_f32 v147, v147
    v_exp_f32 v148, v148
    v_exp_f32 v149, v149
    v_smfmac_f32_32x32x32_bf16 v[64:79], v[188:191], v[136:143], v8
    s_waitcnt lgkmcnt(0)
    v_exp_f32 v150, v150
    v_exp_f32 v151, v151
    v_exp_f32 v160, v160
    v_exp_f32 v161, v161
    v_mfma_f32_32x32x16_bf16 v[112:127], v[176:179], v[16:19], 0
    v_exp_f32 v162, v162
    v_exp_f32 v163, v163
    v_exp_f32 v164, v164
    v_exp_f32 v165, v165
    v_mfma_f32_32x32x16_bf16 v[128:143], v[176:179], v[24:27], 0
    v_exp_f32 v166, v166
    v_exp_f32 v167, v167
    v_exp_f32 v152, v152
    v_exp_f32 v153, v153
    v_mfma_f32_32x32x16_bf16 v[112:127], v[180:183], v[20:23], v[112:127]
    v_exp_f32 v154, v154
    v_exp_f32 v155, v155
    v_exp_f32 v156, v156
    v_exp_f32 v157, v157
    v_mfma_f32_32x32x16_bf16 v[128:143], v[180:183], v[28:31], v[128:143]
    v_exp_f32 v158, v158
    v_exp_f32 v159, v159
    v_exp_f32 v168, v168
    v_exp_f32 v169, v169
    v_smfmac_f32_32x32x32_bf16 v[80:95], v[184:187], v[144:151], v8
    v_exp_f32 v170, v170
    v_exp_f32 v171, v171
    v_exp_f32 v172, v172
    v_exp_f32 v173, v173
    v_smfmac_f32_32x32x32_bf16 v[96:111], v[184:187], v[160:167], v8
    ds_read_b64_tr_b16 v[184:185], v6 offset:5376
    s_setprio 0
    v_exp_f32 v174, v174
    v_exp_f32 v175, v175
    v_exp_f32 v112, v112
    v_exp_f32 v113, v113
    v_smfmac_f32_32x32x32_bf16 v[80:95], v[188:191], v[152:159], v8
    ds_read_b64_tr_b16 v[186:187], v6 offset:5600
    v_exp_f32 v114, v114
    v_exp_f32 v115, v115
    v_exp_f32 v116, v116
    v_exp_f32 v117, v117
    v_smfmac_f32_32x32x32_bf16 v[96:111], v[188:191], v[168:175], v8
    ds_read_b64_tr_b16 v[188:189], v6 offset:6272
    v_exp_f32 v118, v118
    v_exp_f32 v119, v119
    v_exp_f32 v128, v128
    v_exp_f32 v129, v129
    v_mfma_f32_32x32x16_bf16 v[144:159], v[176:179], v[32:35], 0
    ds_read_b64_tr_b16 v[190:191], v6 offset:6496
    v_exp_f32 v130, v130
    v_exp_f32 v131, v131
    v_exp_f32 v132, v132
    v_exp_f32 v133, v133
    v_mfma_f32_32x32x16_bf16 v[160:175], v[176:179], v[40:43], 0
    s_waitcnt vmcnt(0) lgkmcnt(0)
    s_barrier
    s_setprio 3
    v_xor_b32 v5, 65536, v5
    v_xor_b32 v6, v7, v6
    s_cmp_eq_u32 s38, 0
    s_cselect_b32 s44, s37, 0
    s_cmp_ge_u32 s44, 2
    s_cbranch_scc0 L_signalled
    s_and_b32 s44, s37, 14
    s_lshl_b32 s44, 1, s44
    v_mov_b32 v12, s44
    v_mov_b32 v11, 0
    s_lshl_b32 s44, s36, 4
    s_mov_b64 exec, 1
    buffer_atomic_add v12, v11, s[32:35], s44 offen sc1
    s_mov_b64 exec, -1
L_signalled:
    ds_read_b128 v[176:179], v5 offset:0
    v_exp_f32 v134, v134
    v_exp_f32 v135, v135
    v_exp_f32 v120, v120
    v_exp_f32 v121, v121
    v_mfma_f32_32x32x16_bf16 v[144:159], v[180:183], v[36:39], v[144:159]
    s_add_u32 s49, s49, 32768
    v_exp_f32 v122, v122
    v_exp_f32 v123, v123
    v_exp_f32 v124, v124
    v_exp_f32 v125, v125
    v_mfma_f32_32x32x16_bf16 v[160:175], v[180:183], v[44:47], v[160:175]
    ds_read_b128 v[180:183], v5 offset:1024
    s_waitcnt lgkmcnt(2)
    v_exp_f32 v126, v126
    v_exp_f32 v127, v127
    v_exp_f32 v136, v136
    v_exp_f32 v137, v137
    v_smfmac_f32_32x32x32_bf16 v[48:63], v[184:187], v[112:119], v8
    s_add_u32 s41, s41, 28672
    s_xor_b32 s47, s47, 65536
    v_exp_f32 v138, v138
    v_exp_f32 v139, v139
    v_exp_f32 v140, v140
    v_exp_f32 v141, v141
    v_smfmac_f32_32x32x32_bf16 v[64:79], v[184:187], v[128:135], v8
    v_exp_f32 v142, v142
    v_exp_f32 v143, v143
    v_exp_f32 v144, v144
    v_exp_f32 v145, v145
    v_smfmac_f32_32x32x32_bf16 v[48:63], v[188:191], v[120:127], v8
    s_cmp_eq_u32 s49, 262144
    v_exp_f32 v146, v146
    v_exp_f32 v147, v147
    v_exp_f32 v148, v148
    v_exp_f32 v149, v149
    v_smfmac_f32_32x32x32_bf16 v[64:79], v[188:191], v[136:143], v8
    s_waitcnt lgkmcnt(0)
    v_exp_f32 v150, v150
    v_exp_f32 v151, v151
    v_exp_f32 v160, v160
    v_exp_f32 v161, v161
    v_mfma_f32_32x32x16_bf16 v[112:127], v[176:179], v[16:19], 0
    v_exp_f32 v162, v162
    v_exp_f32 v163, v163
    v_exp_f32 v164, v164
    v_exp_f32 v165, v165
    v_mfma_f32_32x32x16_bf16 v[128:143], v[176:179], v[24:27], 0
    v_exp_f32 v166, v166
    v_exp_f32 v167, v167
    v_exp_f32 v152, v152
    v_exp_f32 v153, v153
    v_mfma_f32_32x32x16_bf16 v[112:127], v[180:183], v[20:23], v[112:127]
    s_cselect_b32 s49, 32768, s49
    v_exp_f32 v154, v154
    v_exp_f32 v155, v155
    v_exp_f32 v156, v156
    v_exp_f32 v157, v157
    v_mfma_f32_32x32x16_bf16 v[128:143], v[180:183], v[28:31], v[128:143]
    v_exp_f32 v158, v158
    v_exp_f32 v159, v159
    v_exp_f32 v168, v168
    v_exp_f32 v169, v169
    v_smfmac_f32_32x32x32_bf16 v[80:95], v[184:187], v[144:151], v8
    s_cselect_b32 s41, 28672, s41
    v_exp_f32 v170, v170
    v_exp_f32 v171, v171
    v_exp_f32 v172, v172
    v_exp_f32 v173, v173
    v_smfmac_f32_32x32x32_bf16 v[96:111], v[184:187], v[160:167], v8
    ds_read_b64_tr_b16 v[184:185], v6 offset:0
    v_exp_f32 v174, v174
    v_exp_f32 v175, v175
    s_mov_b32 s40, 1
L_hook:
    v_exp_f32 v112, v112
    v_exp_f32 v113, v113
    v_smfmac_f32_32x32x32_bf16 v[80:95], v[188:191], v[152:159], v8
    ds_read_b64_tr_b16 v[186:187], v6 offset:224
    s_xor_b32 m0, s42, s47
    v_exp_f32 v114, v114
    v_exp_f32 v115, v115
    v_exp_f32 v116, v116
    v_exp_f32 v117, v117
    v_smfmac_f32_32x32x32_bf16 v[96:111], v[188:191], v[168:175], v8
    ds_read_b64_tr_b16 v[188:189], v6 offset:896
    v_exp_f32 v118, v118
    v_exp_f32 v119, v119
    v_exp_f32 v128, v128
    v_exp_f32 v129, v129
    v_mfma_f32_32x32x16_bf16 v[144:159], v[176:179], v[32:35], 0
    ds_read_b64_tr_b16 v[190:191], v6 offset:1120
    v_exp_f32 v130, v130
    v_exp_f32 v131, v131
    v_exp_f32 v132, v132
    v_exp_f32 v133, v133
    v_mfma_f32_32x32x16_bf16 v[160:175], v[176:179], v[40:43], 0
    ds_read_b128 v[176:179], v5 offset:2048
    v_exp_f32 v134, v134
    v_exp_f32 v135, v135
    v_exp_f32 v120, v120
    v_exp_f32 v121, v121
    v_mfma_f32_32x32x16_bf16 v[144:159], v[180:183], v[36:39], v[144:159]
    buffer_load_dwordx4 v3, s[20:23], s41 offen offset:0 lds
    v_exp_f32 v122, v122
    v_exp_f32 v123, v123
    v_exp_f32 v124, v124
    v_exp_f32 v125, v125
    v_mfma_f32_32x32x16_bf16 v[160:175], v[180:183], v[44:47], v[160:175]
    ds_read_b128 v[180:183], v5 offset:3072
    s_waitcnt lgkmcnt(2)
    v_exp_f32 v126, v126
    v_exp_f32 v127, v127
    v_exp_f32 v136, v136
    v_exp_f32 v137, v137
    v_smfmac_f32_32x32x32_bf16 v[48:63], v[184:187], v[112:119], v8
    buffer_load_dwordx4 v3, s[20:23], s41 offen offset:1024 lds
    v_exp_f32 v138, v138
    v_exp_f32 v139, v139
    v_exp_f32 v140, v140
    v_exp_f32 v141, v141
    v_smfmac_f32_32x32x32_bf16 v[64:79], v[184:187], v[128:135], v8
    v_exp_f32 v142, v142
    v_exp_f32 v143, v143
    s_cmp_eq_u32 s38, 0
    s_cselect_b32 s44, s40, 0
    s_cmp_ge_u32 s44, 2
    s_cbranch_scc1 L_repoll
L_repolled:
    v_exp_f32 v144, v144
    v_exp_f32 v145, v145
    v_smfmac_f32_32x32x32_bf16 v[48:63], v[188:191], v[120:127], v8
    v_exp_f32 v146, v146
    v_exp_f32 v147, v147
    v_exp_f32 v148, v148
    v_exp_f32 v149, v149
    v_smfmac_f32_32x32x32_bf16 v[64:79], v[188:191], v[136:143], v8
    s_waitcnt lgkmcnt(0)
    v_exp_f32 v150, v150
    v_exp_f32 v151, v151
    v_exp_f32 v160, v160
    v_exp_f32 v161, v161
    v_mfma_f32_32x32x16_bf16 v[112:127], v[176:179], v[16:19], 0
    v_exp_f32 v162, v162
    v_exp_f32 v163, v163
    v_exp_f32 v164, v164
    v_exp_f32 v165, v165
    v_mfma_f32_32x32x16_bf16 v[128:143], v[176:179], v[24:27], 0
    v_exp_f32 v166, v166
    v_exp_f32 v167, v167
    v_exp_f32 v152, v152
    v_exp_f32 v153, v153
    v_mfma_f32_32x32x16_bf16 v[112:127], v[180:183], v[20:23], v[112:127]
    buffer_load_dwordx4 v3, s[20:23], s41 offen offset:2048 lds
    v_exp_f32 v154, v154
    v_exp_f32 v155, v155
    v_exp_f32 v156, v156
    v_exp_f32 v157, v157
    v_mfma_f32_32x32x16_bf16 v[128:143], v[180:183], v[28:31], v[128:143]
    v_exp_f32 v158, v158
    v_exp_f32 v159, v159
    v_exp_f32 v168, v168
    v_exp_f32 v169, v169
    v_smfmac_f32_32x32x32_bf16 v[80:95], v[184:187], v[144:151], v8
    buffer_load_dwordx4 v3, s[20:23], s41 offen offset:3072 lds
    v_exp_f32 v170, v170
    v_exp_f32 v171, v171
    v_exp_f32 v172, v172
    v_exp_f32 v173, v173
    v_smfmac_f32_32x32x32_bf16 v[96:111], v[184:187], v[160:167], v8
    ds_read_b64_tr_b16 v[184:185], v6 offset:1792
    v_exp_f32 v174, v174
    v_exp_f32 v175, v175
    v_exp_f32 v112, v112
    v_exp_f32 v113, v113
    v_smfmac_f32_32x32x32_bf16 v[80:95], v[188:191], v[152:159], v8
    ds_read_b64_tr_b16 v[186:187], v6 offset:2016
    v_exp_f32 v114, v114
    v_exp_f32 v115, v115
    v_exp_f32 v116, v116
    v_exp_f32 v117, v117
    v_smfmac_f32_32x32x32_bf16 v[96:111], v[188:191], v[168:175], v8
    ds_read_b64_tr_b16 v[188:189], v6 offset:2688
    v_exp_f32 v118, v118
    v_exp_f32 v119, v119
    v_exp_f32 v128, v128
    v_exp_f32 v129, v129
    v_mfma_f32_32x32x16_bf16 v[144:159], v[176:179], v[32:35], 0
    ds_read_b64_tr_b16 v[190:191], v6 offset:2912
    v_exp_f32 v130, v130
    v_exp_f32 v131, v131
    v_exp_f32 v132, v132
    v_exp_f32 v133, v133
    v_mfma_f32_32x32x16_bf16 v[160:175], v[176:179], v[40:43], 0
    ds_read_b128 v[176:179], v5 offset:4096
    v_exp_f32 v134, v134
    v_exp_f32 v135, v135
    v_exp_f32 v120, v120
    v_exp_f32 v121, v121
    v_mfma_f32_32x32x16_bf16 v[144:159], v[180:183], v[36:39], v[144:159]
    v_exp_f32 v122, v122
    v_exp_f32 v123, v123
    v_exp_f32 v124, v124
    v_exp_f32 v125, v125
    v_mfma_f32_32x32x16_bf16 v[160:175], v[180:183], v[44:47], v[160:175]
    ds_read_b128 v[180:183], v5 offset:5120
    s_waitcnt lgkmcnt(2)
    v_exp_f32 v126, v126
    v_exp_f32 v127, v127
    v_exp_f32 v136, v136
    v_exp_f32 v137, v137
    v_smfmac_f32_32x32x32_bf16 v[48:63], v[184:187], v[112:119], v8
    v_exp_f32 v138, v138
    v_exp_f32 v139, v139
    v_exp_f32 v140, v140
    v_exp_f32 v141, v141
    v_smfmac_f32_32x32x32_bf16 v[64:79], v[184:187], v[128:135], v8
    s_setprio 2
    v_exp_f32 v142, v142
    v_exp_f32 v143, v143
    v_exp_f32 v144, v144
    v_exp_f32 v145, v145
    v_smfmac_f32_32x32x32_bf16 v[48:63], v[188:191], v[120:127], v8
    v_exp_f32 v146, v146
    v_exp_f32 v147, v147
    v_exp_f32 v148, v148
    v_exp_f32 v149, v149
    v_smfmac_f32_32x32x32_bf16 v[64:79], v[188:191], v[136:143], v8
    s_waitcnt lgkmcnt(0)
    v_exp_f32 v150, v150
    v_exp_f32 v151, v151
    v_exp_f32 v160, v160
    v_exp_f32 v161, v161
    v_mfma_f32_32x32x16_bf16 v[112:127], v[176:179], v[16:19], 0
    v_exp_f32 v162, v162
    v_exp_f32 v163, v163
    v_exp_f32 v164, v164
    v_exp_f32 v165, v165
    v_mfma_f32_32x32x16_bf16 v[128:143], v[176:179], v[24:27], 0
    v_exp_f32 v166, v166
    v_exp_f32 v167, v167
    v_exp_f32 v152, v152
    v_exp_f32 v153, v153
    v_mfma_f32_32x32x16_bf16 v[112:127], v[180:183], v[20:23], v[112:127]
    s_cmp_eq_u32 s38, 0
    s_cbranch_scc0 L_polled
    s_cmp_eq_u32 s40, 1
    s_cbranch_scc0 L_relay
    s_mov_b32 m0, 161792
    s_lshl_b32 s44, s36, 4
    v_mov_b32 v11, 0
    s_mov_b64 exec, 1
    buffer_load_dword v11, s[32:35], s44 offen sc1 lds
    s_mov_b64 exec, -1
L_polled:
    v_exp_f32 v154, v154
    v_exp_f32 v155, v155
    v_exp_f32 v156, v156
    v_exp_f32 v157, v157
    v_mfma_f32_32x32x16_bf16 v[128:143], v[180:183], v[28:31], v[128:143]
    v_exp_f32 v158, v158
    v_exp_f32 v159, v159
    v_exp_f32 v168, v168
    v_exp_f32 v169, v169
    v_smfmac_f32_32x32x32_bf16 v[80:95], v[184:187], v[144:151], v8
    v_exp_f32 v170, v170
    v_exp_f32 v171, v171
    v_exp_f32 v172, v172
    v_exp_f32 v173, v173
    v_smfmac_f32_32x32x32_bf16 v[96:111], v[184:187], v[160:167], v8
    ds_read_b64_tr_b16 v[184:185], v6 offset:3584
    s_setprio 1
    v_exp_f32 v174, v174
    v_exp_f32 v175, v175
    v_exp_f32 v112, v112
    v_exp_f32 v113, v113
    v_smfmac_f32_32x32x32_bf16 v[80:95], v[188:191], v[152:159], v8
    ds_read_b64_tr_b16 v[186:187], v6 offset:3808
    v_exp_f32 v114, v114
    v_exp_f32 v115, v115
    v_exp_f32 v116, v116
    v_exp_f32 v117, v117
    v_smfmac_f32_32x32x32_bf16 v[96:111], v[188:191], v[168:175], v8
    ds_read_b64_tr_b16 v[188:189], v6 offset:4480
    v_exp_f32 v118, v118
    v_exp_f32 v119, v119
    v_exp_f32 v128, v128
    v_exp_f32 v129, v129
    v_mfma_f32_32x32x16_bf16 v[144:159], v[176:179], v[32:35], 0
    ds_read_b64_tr_b16 v[190:191], v6 offset:4704
    v_exp_f32 v130, v130
    v_exp_f32 v131, v131
    v_exp_f32 v132, v132
    v_exp_f32 v133, v133
    v_mfma_f32_32x32x16_bf16 v[160:175], v[176:179], v[40:43], 0
    ds_read_b128 v[176:179], v5 offset:6144
    v_exp_f32 v134, v134
    v_exp_f32 v135, v135
    v_exp_f32 v120, v120
    v_exp_f32 v121, v121
    v_mfma_f32_32x32x16_bf16 v[144:159], v[180:183], v[36:39], v[144:159]
    v_exp_f32 v122, v122
    v_exp_f32 v123, v123
    v_exp_f32 v124, v124
    v_exp_f32 v125, v125
    v_mfma_f32_32x32x16_bf16 v[160:175], v[180:183], v[44:47], v[160:175]
    ds_read_b128 v[180:183], v5 offset:7168
    s_waitcnt lgkmcnt(2)
    v_exp_f32 v126, v126
    v_exp_f32 v127, v127
    v_exp_f32 v136, v136
    v_exp_f32 v137, v137
    v_smfmac_f32_32x32x32_bf16 v[48:63], v[184:187], v[112:119], v8
    v_exp_f32 v138, v138
    v_exp_f32 v139, v139
    v_exp_f32 v140, v140
    v_exp_f32 v141, v141
    v_smfmac_f32_32x32x32_bf16 v[64:79], v[184:187], v[128:135], v8
    s_setprio 0
    v_exp_f32 v142, v142
    v_exp_f32 v143, v143
    v_mov_b32 v11, 161792
    ds_read_b32 v11, v11
    s_xor_b32 m0, s48, s47
    s_lshr_b32 s45, s49, 14
    s_add_u32 s45, s45, 1
    s_waitcnt lgkmcnt(0)
    v_readfirstlane_b32 s44, v11
    s_cmp_eq_u32 s44, 0xaaa8
    s_cselect_b32 s51, 1, 0
    s_bitcmp1_b32 s44, s45
    s_cbranch_scc0 L_raw
    buffer_load_dwordx4 v2, s[28:31], s49 offen offset:0 sc1 lds
    buffer_load_dwordx4 v2, s[28:31], s49 offen offset:1024 sc1 lds
    buffer_load_dwordx4 v2, s[28:31], s49 offen offset:2048 sc1 lds
    buffer_load_dwordx4 v2, s[28:31], s49 offen offset:3072 sc1 lds
L_kdone:
    v_exp_f32 v144, v144
    v_exp_f32 v145, v145
    v_smfmac_f32_32x32x32_bf16 v[48:63], v[188:191], v[120:127], v8
    v_exp_f32 v146, v146
    v_exp_f32 v147, v147
    v_exp_f32 v148, v148
    v_exp_f32 v149, v149
    v_smfmac_f32_32x32x32_bf16 v[64:79], v[188:191], v[136:143], v8
    s_waitcnt lgkmcnt(0)
    v_exp_f32 v150, v150
    v_exp_f32 v151, v151
    v_exp_f32 v160, v160
    v_exp_f32 v161, v161
    v_mfma_f32_32x32x16_bf16 v[112:127], v[176:179], v[16:19], 0
    v_exp_f32 v162, v162
    v_exp_f32 v163, v163
    v_exp_f32 v164, v164
    v_exp_f32 v165, v165
    v_mfma_f32_32x32x16_bf16 v[128:143], v[176:179], v[24:27], 0
    v_exp_f32 v166, v166
    v_exp_f32 v167, v167
    v_exp_f32 v152, v152
    v_exp_f32 v153, v153
    v_mfma_f32_32x32x16_bf16 v[112:127], v[180:183], v[20:23], v[112:127]
    v_exp_f32 v154, v154
    v_exp_f32 v155, v155
    v_exp_f32 v156, v156
    v_exp_f32 v157, v157
    v_mfma_f32_32x32x16_bf16 v[128:143], v[180:183], v[28:31], v[128:143]
    v_exp_f32 v158, v158
    v_exp_f32 v159, v159
    v_exp_f32 v168, v168
    v_exp_f32 v169, v169
    v_smfmac_f32_32x32x32_bf16 v[80:95], v[184:187], v[144:151], v8
    v_exp_f32 v170, v170
    v_exp_f32 v171, v171
    v_exp_f32 v172, v172
    v_exp_f32 v173, v173
    v_smfmac_f32_32x32x32_bf16 v[96:111], v[184:187], v[160:167], v8
    ds_read_b64_tr_b16 v[184:185], v6 offset:5376
    v_exp_f32 v174, v174
    v_exp_f32 v175, v175
    s_cmp_eq_u32 s50, 1
    s_cbranch_scc1 L_lump
L_lumped:
    v_exp_f32 v112, v112
    v_exp_f32 v113, v113
    v_smfmac_f32_32x32x32_bf16 v[80:95], v[188:191], v[152:159], v8
    ds_read_b64_tr_b16 v[186:187], v6 offset:5600
    v_exp_f32 v114, v114
    v_exp_f32 v115, v115
    v_exp_f32 v116, v116
    v_exp_f32 v117, v117
    v_smfmac_f32_32x32x32_bf16 v[96:111], v[188:191], v[168:175], v8
    ds_read_b64_tr_b16 v[188:189], v6 offset:6272
    v_exp_f32 v118, v118
    v_exp_f32 v119, v119
    v_exp_f32 v128, v128
    v_exp_f32 v129, v129
    v_mfma_f32_32x32x16_bf16 v[144:159], v[176:179], v[32:35], 0
    ds_read_b64_tr_b16 v[190:191], v6 offset:6496
    v_exp_f32 v130, v130
    v_exp_f32 v131, v131
    v_exp_f32 v132, v132
    v_exp_f32 v133, v133
    v_mfma_f32_32x32x16_bf16 v[160:175], v[176:179], v[40:43], 0
    s_waitcnt vmcnt(0) lgkmcnt(0)
    s_barrier
    s_setprio 3
    v_xor_b32 v5, 65536, v5
    v_xor_b32 v6, v7, v6
    ds_read_b128 v[176:179], v5 offset:0
    v_exp_f32 v134, v134
    v_exp_f32 v135, v135
    v_exp_f32 v120, v120
    v_exp_f32 v121, v121
    v_mfma_f32_32x32x16_bf16 v[144:159], v[180:183], v[36:39], v[144:159]
    s_add_u32 s49, s49, 32768
    v_exp_f32 v122, v122
    v_exp_f32 v123, v123
    v_exp_f32 v124, v124
    v_exp_f32 v125, v125
    v_mfma_f32_32x32x16_bf16 v[160:175], v[180:183], v[44:47], v[160:175]
    ds_read_b128 v[180:183], v5 offset:1024
    s_waitcnt lgkmcnt(2)
    v_exp_f32 v126, v126
    v_exp_f32 v127, v127
    v_exp_f32 v136, v136
    v_exp_f32 v137, v137
    v_smfmac_f32_32x32x32_bf16 v[48:63], v[184:187], v[112:119], v8
    s_add_u32 s41, s41, 28672
    s_xor_b32 s47, s47, 65536
    v_exp_f32 v138, v138
    v_exp_f32 v139, v139
    v_exp_f32 v140, v140
    v_exp_f32 v141, v141
    v_smfmac_f32_32x32x32_bf16 v[64:79], v[184:187], v[128:135], v8
    v_exp_f32 v142, v142
    v_exp_f32 v143, v143
    s_cmp_eq_u32 s40, 7
    s_cbranch_scc1 L_last
    v_exp_f32 v144, v144
    v_exp_f32 v145, v145
    v_smfmac_f32_32x32x32_bf16 v[48:63], v[188:191], v[120:127], v8
    s_cmp_eq_u32 s49, 262144
    v_exp_f32 v146, v146
    v_exp_f32 v147, v147
    v_exp_f32 v148, v148
    v_exp_f32 v149, v149
    v_smfmac_f32_32x32x32_bf16 v[64:79], v[188:191], v[136:143], v8
    s_waitcnt lgkmcnt(0)
    v_exp_f32 v150, v150
    v_exp_f32 v151, v151
    v_exp_f32 v160, v160
    v_exp_f32 v161, v161
    v_mfma_f32_32x32x16_bf16 v[112:127], v[176:179], v[16:19], 0
    v_exp_f32 v162, v162
    v_exp_f32 v163, v163
    v_exp_f32 v164, v164
    v_exp_f32 v165, v165
    v_mfma_f32_32x32x16_bf16 v[128:143], v[176:179], v[24:27], 0
    v_exp_f32 v166, v166
    v_exp_f32 v167, v167
    v_exp_f32 v152, v152
    v_exp_f32 v153, v153
    v_mfma_f32_32x32x16_bf16 v[112:127], v[180:183], v[20:23], v[112:127]
    s_cselect_b32 s49, 32768, s49
    v_exp_f32 v154, v154
    v_exp_f32 v155, v155
    v_exp_f32 v156, v156
    v_exp_f32 v157, v157
    v_mfma_f32_32x32x16_bf16 v[128:143], v[180:183], v[28:31], v[128:143]
    v_exp_f32 v158, v158
    v_exp_f32 v159, v159
    v_exp_f32 v168, v168
    v_exp_f32 v169, v169
    v_smfmac_f32_32x32x32_bf16 v[80:95], v[184:187], v[144:151], v8
    s_cselect_b32 s41, 28672, s41
    v_exp_f32 v170, v170
    v_exp_f32 v171, v171
    v_exp_f32 v172, v172
    v_exp_f32 v173, v173
    v_smfmac_f32_32x32x32_bf16 v[96:111], v[184:187], v[160:167], v8
    ds_read_b64_tr_b16 v[184:185], v6 offset:0
    v_exp_f32 v174, v174
    v_exp_f32 v175, v175
    s_add_u32 s40, s40, 1
    s_cmp_eq_u32 s51, 0
    s_cbranch_scc1 L_hook
.p2align 6
L_lean:
    v_exp_f32 v112, v112
    v_exp_f32 v113, v113
    v_smfmac_f32_32x32x32_bf16 v[80:95], v[188:191], v[152:159], v8
    ds_read_b64_tr_b16 v[186:187], v6 offset:224
    s_xor_b32 m0, s42, s47
    v_exp_f32 v114, v114
    v_exp_f32 v115, v115
    v_exp_f32 v116, v116
    v_exp_f32 v117, v117
    v_smfmac_f32_32x32x32_bf16 v[96:111], v[188:191], v[168:175], v8
    ds_read_b64_tr_b16 v[188:189], v6 offset:896
    v_exp_f32 v118, v118
    v_exp_f32 v119, v119
    v_exp_f32 v128, v128
    v_exp_f32 v129, v129
    v_mfma_f32_32x32x16_bf16 v[144:159], v[176:179], v[32:35], 0
    ds_read_b64_tr_b16 v[190:191], v6 offset:1120
    v_exp_f32 v130, v130
    v_exp_f32 v131, v131
    v_exp_f32 v132, v132
    v_exp_f32 v133, v133
    v_mfma_f32_32x32x16_bf16 v[160:175], v[176:179], v[40:43], 0
    ds_read_b128 v[176:179], v5 offset:2048
    v_exp_f32 v134, v134
    v_exp_f32 v135, v135
    v_exp_f32 v120, v120
    v_exp_f32 v121, v121
    v_mfma_f32_32x32x16_bf16 v[144:159], v[180:183], v[36:39], v[144:159]
    buffer_load_dwordx4 v3, s[20:23], s41 offen offset:0 lds
    v_exp_f32 v122, v122
    v_exp_f32 v123, v123
    v_exp_f32 v124, v124
    v_exp_f32 v125, v125
    v_mfma_f32_32x32x16_bf16 v[160:175], v[180:183], v[44:47], v[160:175]
    ds_read_b128 v[180:183], v5 offset:3072
    s_waitcnt lgkmcnt(2)
    v_exp_f32 v126, v126
    v_exp_f32 v127, v127
    v_exp_f32 v136, v136
    v_exp_f32 v137, v137
    v_smfmac_f32_32x32x32_bf16 v[48:63], v[184:187], v[112:119], v8
    buffer_load_dwordx4 v3, s[20:23], s41 offen offset:1024 lds
    v_exp_f32 v138, v138
    v_exp_f32 v139, v139
    v_exp_f32 v140, v140
    v_exp_f32 v141, v141
    v_smfmac_f32_32x32x32_bf16 v[64:79], v[184:187], v[128:135], v8
    v_exp_f32 v142, v142
    v_exp_f32 v143, v143
    v_exp_f32 v144, v144
    v_exp_f32 v145, v145
    v_smfmac_f32_32x32x32_bf16 v[48:63], v[188:191], v[120:127], v8
    v_exp_f32 v146, v146
    v_exp_f32 v147, v147
    v_exp_f32 v148, v148
    v_exp_f32 v149, v149
    v_smfmac_f32_32x32x32_bf16 v[64:79], v[188:191], v[136:143], v8
    s_waitcnt lgkmcnt(0)
    v_exp_f32 v150, v150
    v_exp_f32 v151, v151
    v_exp_f32 v160, v160
    v_exp_f32 v161, v161
    v_mfma_f32_32x32x16_bf16 v[112:127], v[176:179], v[16:19], 0
    v_exp_f32 v162, v162
    v_exp_f32 v163, v163
    v_exp_f32 v164, v164
    v_exp_f32 v165, v165
    v_mfma_f32_32x32x16_bf16 v[128:143], v[176:179], v[24:27], 0
    v_exp_f32 v166, v166
    v_exp_f32 v167, v167
    v_exp_f32 v152, v152
    v_exp_f32 v153, v153
    v_mfma_f32_32x32x16_bf16 v[112:127], v[180:183], v[20:23], v[112:127]
    buffer_load_dwordx4 v3, s[20:23], s41 offen offset:2048 lds
    v_exp_f32 v154, v154
    v_exp_f32 v155, v155
    v_exp_f32 v156, v156
    v_exp_f32 v157, v157
    v_mfma_f32_32x32x16_bf16 v[128:143], v[180:183], v[28:31], v[128:143]
    v_exp_f32 v158, v158
    v_exp_f32 v159, v159
    v_exp_f32 v168, v168
    v_exp_f32 v169, v169
    v_smfmac_f32_32x32x32_bf16 v[80:95], v[184:187], v[144:151], v8
    buffer_load_dwordx4 v3, s[20:23], s41 offen offset:3072 lds
    v_exp_f32 v170, v170
    v_exp_f32 v171, v171
    v_exp_f32 v172, v172
    v_exp_f32 v173, v173
    v_smfmac_f32_32x32x32_bf16 v[96:111], v[184:187], v[160:167], v8
    ds_read_b64_tr_b16 v[184:185], v6 offset:1792
    v_exp_f32 v174, v174
    v_exp_f32 v175, v175
    v_exp_f32 v112, v112
    v_exp_f32 v113, v113
    v_smfmac_f32_32x32x32_bf16 v[80:95], v[188:191], v[152:159], v8
    ds_read_b64_tr_b16 v[186:187], v6 offset:2016
    s_xor_b32 m0, s48, s47
    v_exp_f32 v114, v114
    v_exp_f32 v115, v115
    v_exp_f32 v116, v116
    v_exp_f32 v117, v117
    v_smfmac_f32_32x32x32_bf16 v[96:111], v[188:191], v[168:175], v8
    ds_read_b64_tr_b16 v[188:189], v6 offset:2688
    v_exp_f32 v118, v118
    v_exp_f32 v119, v119
    v_exp_f32 v128, v128
    v_exp_f32 v129, v129
    v_mfma_f32_32x32x16_bf16 v[144:159], v[176:179], v[32:35], 0
    ds_read_b64_tr_b16 v[190:191], v6 offset:2912
    v_exp_f32 v130, v130
    v_exp_f32 v131, v131
    v_exp_f32 v132, v132
    v_exp_f32 v133, v133
    v_mfma_f32_32x32x16_bf16 v[160:175], v[176:179], v[40:43], 0
    ds_read_b128 v[176:179], v5 offset:4096
    v_exp_f32 v134, v134
    v_exp_f32 v135, v135
    v_exp_f32 v120, v120
    v_exp_f32 v121, v121
    v_mfma_f32_32x32x16_bf16 v[144:159], v[180:183], v[36:39], v[144:159]
    buffer_load_dwordx4 v2, s[28:31], s49 offen offset:0 sc1 lds
    v_exp_f32 v122, v122
    v_exp_f32 v123, v123
    v_exp_f32 v124, v124
    v_exp_f32 v125, v125
    v_mfma_f32_32x32x16_bf16 v[160:175], v[180:183], v[44:47], v[160:175]
    ds_read_b128 v[180:183], v5 offset:5120
    s_waitcnt lgkmcnt(2)
    v_exp_f32 v126, v126
    v_exp_f32 v127, v127
    v_exp_f32 v136, v136
    v_exp_f32 v137, v137
    v_smfmac_f32_32x32x32_bf16 v[48:63], v[184:187], v[112:119], v8
    buffer_load_dwordx4 v2, s[28:31], s49 offen offset:1024 sc1 lds
    v_exp_f32 v138, v138
    v_exp_f32 v139, v139
    v_exp_f32 v140, v140
    v_exp_f32 v141, v141
    v_smfmac_f32_32x32x32_bf16 v[64:79], v[184:187], v[128:135], v8
    v_exp_f32 v142, v142
    v_exp_f32 v143, v143
    v_exp_f32 v144, v144
    v_exp_f32 v145, v145
    v_smfmac_f32_32x32x32_bf16 v[48:63], v[188:191], v[120:127], v8
    v_exp_f32 v146, v146
    v_exp_f32 v147, v147
    v_exp_f32 v148, v148
    v_exp_f32 v149, v149
    v_smfmac_f32_32x32x32_bf16 v[64:79], v[188:191], v[136:143], v8
    s_waitcnt lgkmcnt(0)
    v_exp_f32 v150, v150
    v_exp_f32 v151, v151
    v_exp_f32 v160, v160
    v_exp_f32 v161, v161
    v_mfma_f32_32x32x16_bf16 v[112:127], v[176:179], v[16:19], 0
    v_exp_f32 v162, v162
    v_exp_f32 v163, v163
    v_exp_f32 v164, v164
    v_exp_f32 v165, v165
    v_mfma_f32_32x32x16_bf16 v[128:143], v[176:179], v[24:27], 0
    v_exp_f32 v166, v166
    v_exp_f32 v167, v167
    v_exp_f32 v152, v152
    v_exp_f32 v153, v153
    v_mfma_f32_32x32x16_bf16 v[112:127], v[180:183], v[20:23], v[112:127]
    buffer_load_dwordx4 v2, s[28:31], s49 offen offset:2048 sc1 lds
    v_exp_f32 v154, v154
    v_exp_f32 v155, v155
    v_exp_f32 v156, v156
    v_exp_f32 v157, v157
    v_mfma_f32_32x32x16_bf16 v[128:143], v[180:183], v[28:31], v[128:143]
    v_exp_f32 v158, v158
    v_exp_f32 v159, v159
    v_exp_f32 v168, v168
    v_exp_f32 v169, v169
    v_smfmac_f32_32x32x32_bf16 v[80:95], v[184:187], v[144:151], v8
    buffer_load_dwordx4 v2, s[28:31], s49 offen offset:3072 sc1 lds
    v_exp_f32 v170, v170
    v_exp_f32 v171, v171
    v_exp_f32 v172, v172
    v_exp_f32 v173, v173
    v_smfmac_f32_32x32x32_bf16 v[96:111], v[184:187], v[160:167], v8
    ds_read_b64_tr_b16 v[184:185], v6 offset:3584
    s_setprio 2
    v_exp_f32 v174, v174
    v_exp_f32 v175, v175
    v_exp_f32 v112, v112
    v_exp_f32 v113, v113
    v_smfmac_f32_32x32x32_bf16 v[80:95], v[188:191], v[152:159], v8
    ds_read_b64_tr_b16 v[186:187], v6 offset:3808
    v_exp_f32 v114, v114
    v_exp_f32 v115, v115
    v_exp_f32 v116, v116
    v_exp_f32 v117, v117
    v_smfmac_f32_32x32x32_bf16 v[96:111], v[188:191], v[168:175], v8
    ds_read_b64_tr_b16 v[188:189], v6 offset:4480
    v_exp_f32 v118, v118
    v_exp_f32 v119, v119
    v_exp_f32 v128, v128
    v_exp_f32 v129, v129
    v_mfma_f32_32x32x16_bf16 v[144:159], v[176:179], v[32:35], 0
    ds_read_b64_tr_b16 v[190:191], v6 offset:4704
    v_exp_f32 v130, v130
    v_exp_f32 v131, v131
    v_exp_f32 v132, v132
    v_exp_f32 v133, v133
    v_mfma_f32_32x32x16_bf16 v[160:175], v[176:179], v[40:43], 0
    ds_read_b128 v[176:179], v5 offset:6144
    v_exp_f32 v134, v134
    v_exp_f32 v135, v135
    v_exp_f32 v120, v120
    v_exp_f32 v121, v121
    v_mfma_f32_32x32x16_bf16 v[144:159], v[180:183], v[36:39], v[144:159]
    v_exp_f32 v122, v122
    v_exp_f32 v123, v123
    v_exp_f32 v124, v124
    v_exp_f32 v125, v125
    v_mfma_f32_32x32x16_bf16 v[160:175], v[180:183], v[44:47], v[160:175]
    ds_read_b128 v[180:183], v5 offset:7168
    s_waitcnt lgkmcnt(2)
    v_exp_f32 v126, v126
    v_exp_f32 v127, v127
    v_exp_f32 v136, v136
    v_exp_f32 v137, v137
    v_smfmac_f32_32x32x32_bf16 v[48:63], v[184:187], v[112:119], v8
    v_exp_f32 v138, v138
    v_exp_f32 v139, v139
    v_exp_f32 v140, v140
    v_exp_f32 v141, v141
    v_smfmac_f32_32x32x32_bf16 v[64:79], v[184:187], v[128:135], v8
    v_exp_f32 v142, v142
    v_exp_f32 v143, v143
    v_exp_f32 v144, v144
    v_exp_f32 v145, v145
    v_smfmac_f32_32x32x32_bf16 v[48:63], v[188:191], v[120:127], v8
    s_setprio 1
    v_exp_f32 v146, v146
    v_exp_f32 v147, v147
    v_exp_f32 v148, v148
    v_exp_f32 v149, v149
    v_smfmac_f32_32x32x32_bf16 v[64:79], v[188:191], v[136:143], v8
    s_waitcnt lgkmcnt(0)
    v_exp_f32 v150, v150
    v_exp_f32 v151, v151
    v_exp_f32 v160, v160
    v_exp_f32 v161, v161
    v_mfma_f32_32x32x16_bf16 v[112:127], v[176:179], v[16:19], 0
    v_exp_f32 v162, v162
    v_exp_f32 v163, v163
    v_exp_f32 v164, v164
    v_exp_f32 v165, v165
    v_mfma_f32_32x32x16_bf16 v[128:143], v[176:179], v[24:27], 0
    v_exp_f32 v166, v166
    v_exp_f32 v167, v167
    v_exp_f32 v152, v152
    v_exp_f32 v153, v153
    v_mfma_f32_32x32x16_bf16 v[112:127], v[180:183], v[20:23], v[112:127]
    s_cmp_eq_u32 s40, 6
    v_exp_f32 v154, v154
    v_exp_f32 v155, v155
    v_exp_f32 v156, v156
    v_exp_f32 v157, v157
    v_mfma_f32_32x32x16_bf16 v[128:143], v[180:183], v[28:31], v[128:143]
    v_exp_f32 v158, v158
    v_exp_f32 v159, v159
    v_exp_f32 v168, v168
    v_exp_f32 v169, v169
    v_smfmac_f32_32x32x32_bf16 v[80:95], v[184:187], v[144:151], v8
    s_cselect_b32 s44, 0x40000000, 0
    v_exp_f32 v170, v170
    v_exp_f32 v171, v171
    v_exp_f32 v172, v172
    v_exp_f32 v173, v173
    v_smfmac_f32_32x32x32_bf16 v[96:111], v[184:187], v[160:167], v8
    ds_read_b64_tr_b16 v[184:185], v6 offset:5376
    v_exp_f32 v174, v174
    v_exp_f32 v175, v175
    v_exp_f32 v112, v112
    v_exp_f32 v113, v113
    v_smfmac_f32_32x32x32_bf16 v[80:95], v[188:191], v[152:159], v8
    ds_read_b64_tr_b16 v[186:187], v6 offset:5600
    s_setprio 0
    v_exp_f32 v114, v114
    v_exp_f32 v115, v115
    v_exp_f32 v116, v116
    v_exp_f32 v117, v117
    v_smfmac_f32_32x32x32_bf16 v[96:111], v[188:191], v[168:175], v8
    ds_read_b64_tr_b16 v[188:189], v6 offset:6272
    v_exp_f32 v118, v118
    v_exp_f32 v119, v119
    v_exp_f32 v128, v128
    v_exp_f32 v129, v129
    v_mfma_f32_32x32x16_bf16 v[144:159], v[176:179], v[32:35], 0
    ds_read_b64_tr_b16 v[190:191], v6 offset:6496
    v_exp_f32 v130, v130
    v_exp_f32 v131, v131
    v_exp_f32 v132, v132
    v_exp_f32 v133, v133
    v_mfma_f32_32x32x16_bf16 v[160:175], v[176:179], v[40:43], 0
    s_waitcnt vmcnt(0) lgkmcnt(0)
    s_barrier
    s_setprio 3
    v_xor_b32 v5, 65536, v5
    v_xor_b32 v6, v7, v6
    ds_read_b128 v[176:179], v5 offset:0
    v_exp_f32 v134, v134
    v_exp_f32 v135, v135
    v_exp_f32 v120, v120
    v_exp_f32 v121, v121
    v_mfma_f32_32x32x16_bf16 v[144:159], v[180:183], v[36:39], v[144:159]
    s_add_u32 s49, s49, 32768
    v_exp_f32 v122, v122
    v_exp_f32 v123, v123
    v_exp_f32 v124, v124
    v_exp_f32 v125, v125
    v_mfma_f32_32x32x16_bf16 v[160:175], v[180:183], v[44:47], v[160:175]
    ds_read_b128 v[180:183], v5 offset:1024
    s_waitcnt lgkmcnt(2)
    v_exp_f32 v126, v126
    v_exp_f32 v127, v127
    v_exp_f32 v136, v136
    v_exp_f32 v137, v137
    v_smfmac_f32_32x32x32_bf16 v[48:63], v[184:187], v[112:119], v8
    s_add_u32 s41, s41, 28672
    s_xor_b32 s47, s47, 65536
    v_exp_f32 v138, v138
    v_exp_f32 v139, v139
    v_exp_f32 v140, v140
    v_exp_f32 v141, v141
    v_smfmac_f32_32x32x32_bf16 v[64:79], v[184:187], v[128:135], v8
    v_exp_f32 v142, v142
    v_exp_f32 v143, v143
    s_cmp_eq_u32 s40, 7
    s_cbranch_scc1 L_last
    v_exp_f32 v144, v144
    v_exp_f32 v145, v145
    v_smfmac_f32_32x32x32_bf16 v[48:63], v[188:191], v[120:127], v8
    s_cmp_eq_u32 s49, 262144
    v_exp_f32 v146, v146
    v_exp_f32 v147, v147
    v_exp_f32 v148, v148
    v_exp_f32 v149, v149
    v_smfmac_f32_32x32x32_bf16 v[64:79], v[188:191], v[136:143], v8
    s_waitcnt lgkmcnt(0)
    v_exp_f32 v150, v150
    v_exp_f32 v151, v151
    v_exp_f32 v160, v160
    v_exp_f32 v161, v161
    v_mfma_f32_32x32x16_bf16 v[112:127], v[176:179], v[16:19], 0
    v_exp_f32 v162, v162
    v_exp_f32 v163, v163
    v_exp_f32 v164, v164
    v_exp_f32 v165, v165
    v_mfma_f32_32x32x16_bf16 v[128:143], v[176:179], v[24:27], 0
    v_exp_f32 v166, v166
    v_exp_f32 v167, v167
    v_exp_f32 v152, v152
    v_exp_f32 v153, v153
    v_mfma_f32_32x32x16_bf16 v[112:127], v[180:183], v[20:23], v[112:127]
    s_cselect_b32 s49, 32768, s49
    v_exp_f32 v154, v154
    v_exp_f32 v155, v155
    v_exp_f32 v156, v156
    v_exp_f32 v157, v157
    v_mfma_f32_32x32x16_bf16 v[128:143], v[180:183], v[28:31], v[128:143]
    v_exp_f32 v158, v158
    v_exp_f32 v159, v159
    v_exp_f32 v168, v168
    v_exp_f32 v169, v169
    v_smfmac_f32_32x32x32_bf16 v[80:95], v[184:187], v[144:151], v8
    s_cselect_b32 s41, 28672, s41
    s_or_b32 s49, s49, s44
    v_exp_f32 v170, v170
    v_exp_f32 v171, v171
    v_exp_f32 v172, v172
    v_exp_f32 v173, v173
    v_smfmac_f32_32x32x32_bf16 v[96:111], v[184:187], v[160:167], v8
    ds_read_b64_tr_b16 v[184:185], v6 offset:0
    s_or_b32 s41, s41, s44
    v_exp_f32 v174, v174
    v_exp_f32 v175, v175
    s_add_u32 s40, s40, 1
    s_branch L_lean
L_last:
    s_lshl_b32 s45, s38, 14
    v_lshl_add_u32 v9, v1, 4, s45
    v_smfmac_f32_32x32x32_bf16 v[48:63], v[188:191], v[120:127], v8
    v_exp_f32 v144, v144
    v_exp_f32 v145, v145
    v_exp_f32 v146, v146
    v_exp_f32 v147, v147
    v_smfmac_f32_32x32x32_bf16 v[64:79], v[188:191], v[136:143], v8
    v_exp_f32 v148, v148
    v_exp_f32 v149, v149
    v_exp_f32 v150, v150
    v_exp_f32 v151, v151
    v_exp_f32 v160, v160
    v_exp_f32 v161, v161
    v_exp_f32 v162, v162
    v_exp_f32 v163, v163
    ds_write_b128 v9, v[48:51] offset:0
    v_exp_f32 v164, v164
    v_exp_f32 v165, v165
    v_exp_f32 v166, v166
    ds_write_b128 v9, v[52:55] offset:1024
    v_exp_f32 v167, v167
    v_exp_f32 v152, v152
    v_exp_f32 v153, v153
    v_smfmac_f32_32x32x32_bf16 v[80:95], v[184:187], v[144:151], v8
    ds_write_b128 v9, v[56:59] offset:2048
    v_exp_f32 v154, v154
    v_exp_f32 v155, v155
    v_exp_f32 v156, v156
    v_exp_f32 v157, v157
    v_smfmac_f32_32x32x32_bf16 v[96:111], v[184:187], v[160:167], v8
    ds_write_b128 v9, v[60:63] offset:3072
    v_exp_f32 v158, v158
    v_exp_f32 v159, v159
    ds_write_b128 v9, v[64:67] offset:4096
    v_exp_f32 v168, v168
    v_exp_f32 v169, v169
    v_smfmac_f32_32x32x32_bf16 v[80:95], v[188:191], v[152:159], v8
    ds_write_b128 v9, v[68:71] offset:5120
    v_exp_f32 v170, v170
    v_exp_f32 v171, v171
    v_exp_f32 v172, v172
    ds_write_b128 v9, v[72:75] offset:6144
    v_exp_f32 v173, v173
    v_exp_f32 v174, v174
    v_exp_f32 v175, v175
    ds_write_b128 v9, v[76:79] offset:7168
    s_nop 0
    v_smfmac_f32_32x32x32_bf16 v[96:111], v[188:191], v[168:175], v8
L_epi:
    s_lshr_b32 s46, s38, 1
    s_lshl_b32 s44, s46, 12
    s_add_u32 s45, s45, s44
    v_and_b32 v11, 31, v0
    v_mul_u32_u24 v11, 56, v11
    v_bfe_u32 v12, v0, 5, 1
    v_lshl_add_u32 v11, v12, 3, v11
    v_add_u32 v11, s45, v11
    v_lshl_add_u32 v5, v1, 4, s45
    v_xor_b32 v14, 0x8000, v5
    v_xor_b32 v15, 0x10000, v5
    v_xor_b32 v10, 0x18000, v5
    s_and_b32 s44, s38, 1
    s_lshl_b32 s44, s44, 2
    s_add_u32 s44, s44, s46
    s_mul_i32 s44, s44, 1792
    s_cmp_eq_u32 s46, 1
    s_cbranch_scc1 L_send1
    s_cmp_eq_u32 s46, 2
    s_cbranch_scc1 L_send2
    s_cmp_eq_u32 s46, 3
    s_cbranch_scc1 L_send3
    ds_write_b128 v9, v[80:83] offset:8192
    v_mov_b64 v[208:209], v[48:49]
    ds_write_b128 v9, v[84:87] offset:9216
    v_mov_b64 v[210:211], v[50:51]
    ds_write_b128 v9, v[88:91] offset:10240
    v_mov_b64 v[212:213], v[52:53]
    ds_write_b128 v9, v[92:95] offset:11264
    v_mov_b64 v[214:215], v[54:55]
    ds_write_b128 v9, v[96:99] offset:12288
    v_mov_b64 v[216:217], v[56:57]
    ds_write_b128 v9, v[100:103] offset:13312
    v_mov_b64 v[218:219], v[58:59]
    ds_write_b128 v9, v[104:107] offset:14336
    v_mov_b64 v[220:221], v[60:61]
    ds_write_b128 v9, v[108:111] offset:15360
    v_mov_b64 v[222:223], v[62:63]
    s_branch L_sent
L_send1:
    ds_write_b128 v9, v[80:83] offset:8192
    v_mov_b64 v[208:209], v[64:65]
    ds_write_b128 v9, v[84:87] offset:9216
    v_mov_b64 v[210:211], v[66:67]
    ds_write_b128 v9, v[88:91] offset:10240
    v_mov_b64 v[212:213], v[68:69]
    ds_write_b128 v9, v[92:95] offset:11264
    v_mov_b64 v[214:215], v[70:71]
    ds_write_b128 v9, v[96:99] offset:12288
    v_mov_b64 v[216:217], v[72:73]
    ds_write_b128 v9, v[100:103] offset:13312
    v_mov_b64 v[218:219], v[74:75]
    ds_write_b128 v9, v[104:107] offset:14336
    v_mov_b64 v[220:221], v[76:77]
    ds_write_b128 v9, v[108:111] offset:15360
    v_mov_b64 v[222:223], v[78:79]
    s_branch L_sent
L_send2:
    ds_write_b128 v9, v[96:99] offset:12288
    v_mov_b64 v[208:209], v[80:81]
    ds_write_b128 v9, v[100:103] offset:13312
    v_mov_b64 v[210:211], v[82:83]
    ds_write_b128 v9, v[104:107] offset:14336
    v_mov_b64 v[212:213], v[84:85]
    ds_write_b128 v9, v[108:111] offset:15360
    v_mov_b64 v[214:215], v[86:87]
    v_mov_b64 v[216:217], v[88:89]
    v_mov_b64 v[218:219], v[90:91]
    v_mov_b64 v[220:221], v[92:93]
    v_mov_b64 v[222:223], v[94:95]
    s_branch L_sent
L_send3:
    ds_write_b128 v9, v[80:83] offset:8192
    v_mov_b64 v[208:209], v[96:97]
    ds_write_b128 v9, v[84:87] offset:9216
    v_mov_b64 v[210:211], v[98:99]
    ds_write_b128 v9, v[88:91] offset:10240
    v_mov_b64 v[212:213], v[100:101]
    ds_write_b128 v9, v[92:95] offset:11264
    v_mov_b64 v[214:215], v[102:103]
    v_mov_b64 v[216:217], v[104:105]
    v_mov_b64 v[218:219], v[106:107]
    v_mov_b64 v[220:221], v[108:109]
    v_mov_b64 v[222:223], v[110:111]
L_sent:
    s_waitcnt lgkmcnt(0)
    s_barrier
    ds_read_b128 v[124:127], v14 offset:3072
    ds_read_b128 v[140:143], v15 offset:3072
    ds_read_b128 v[156:159], v10 offset:3072
    ds_read_b128 v[112:115], v14 offset:0
    ds_read_b128 v[128:131], v15 offset:0
    ds_read_b128 v[144:147], v10 offset:0
    ds_read_b128 v[116:119], v14 offset:1024
    ds_read_b128 v[132:135], v15 offset:1024
    ds_read_b128 v[148:151], v10 offset:1024
    ds_read_b128 v[120:123], v14 offset:2048
    ds_read_b128 v[136:139], v15 offset:2048
    ds_read_b128 v[152:155], v10 offset:2048
    s_waitcnt lgkmcnt(11)
    v_pk_add_f32 v[124:125], v[124:125], v[220:221]
    v_pk_add_f32 v[126:127], v[126:127], v[222:223]
    s_waitcnt lgkmcnt(9)
    v_pk_add_f32 v[140:141], v[140:141], v[156:157]
    v_pk_add_f32 v[142:143], v[142:143], v[158:159]
    v_pk_add_f32 v[124:125], v[124:125], v[140:141]
    v_pk_add_f32 v[126:127], v[126:127], v[142:143]
    v_mov_b32 v13, v124
    v_mov_b32 v12, v124
    s_waitcnt lgkmcnt(8)
    v_pk_add_f32 v[112:113], v[112:113], v[208:209]
    v_pk_add_f32 v[114:115], v[114:115], v[210:211]
    s_waitcnt lgkmcnt(6)
    v_pk_add_f32 v[128:129], v[128:129], v[144:145]
    v_pk_add_f32 v[130:131], v[130:131], v[146:147]
    v_pk_add_f32 v[112:113], v[112:113], v[128:129]
    v_pk_add_f32 v[114:115], v[114:115], v[130:131]
    v_permlane32_swap_b32 v13, v12
    s_waitcnt lgkmcnt(5)
    v_pk_add_f32 v[116:117], v[116:117], v[212:213]
    v_pk_add_f32 v[118:119], v[118:119], v[214:215]
    s_waitcnt lgkmcnt(3)
    v_pk_add_f32 v[132:133], v[132:133], v[148:149]
    v_pk_add_f32 v[134:135], v[134:135], v[150:151]
    v_pk_add_f32 v[116:117], v[116:117], v[132:133]
    v_pk_add_f32 v[118:119], v[118:119], v[134:135]
    v_rcp_f32 v12, v12
    s_waitcnt lgkmcnt(2)
    v_pk_add_f32 v[120:121], v[120:121], v[216:217]
    v_pk_add_f32 v[122:123], v[122:123], v[218:219]
    s_waitcnt lgkmcnt(0)
    v_pk_add_f32 v[136:137], v[136:137], v[152:153]
    v_pk_add_f32 v[138:139], v[138:139], v[154:155]
    v_pk_add_f32 v[120:121], v[120:121], v[136:137]
    v_pk_add_f32 v[122:123], v[122:123], v[138:139]
    v_pk_mul_f32 v[224:225], v[112:113], v[12:13] op_sel_hi:[1,0]
    v_pk_mul_f32 v[226:227], v[114:115], v[12:13] op_sel_hi:[1,0]
    v_cvt_pk_bf16_f32 v192, v224, v225
    v_cvt_pk_bf16_f32 v193, v226, v227
    v_pk_mul_f32 v[228:229], v[116:117], v[12:13] op_sel_hi:[1,0]
    v_pk_mul_f32 v[230:231], v[118:119], v[12:13] op_sel_hi:[1,0]
    ds_write_b64 v11, v[192:193] offset:0
    v_cvt_pk_bf16_f32 v194, v228, v229
    v_cvt_pk_bf16_f32 v195, v230, v231
    v_pk_mul_f32 v[232:233], v[120:121], v[12:13] op_sel_hi:[1,0]
    v_pk_mul_f32 v[234:235], v[122:123], v[12:13] op_sel_hi:[1,0]
    ds_write_b64 v11, v[194:195] offset:16
    v_cvt_pk_bf16_f32 v196, v232, v233
    v_cvt_pk_bf16_f32 v197, v234, v235
    v_pk_mul_f32 v[236:237], v[124:125], v[12:13] op_sel_hi:[1,0]
    v_pk_mul_f32 v[238:239], v[126:127], v[12:13] op_sel_hi:[1,0]
    ds_write_b64 v11, v[196:197] offset:32
    v_cvt_pk_bf16_f32 v198, v236, v237
    v_cvt_pk_bf16_f32 v199, v238, v239
    s_mov_b32 exec_hi, 0
    ds_write_b64 v11, v[198:199] offset:48
    s_mov_b32 exec_hi, -1
    v_lshlrev_b32 v10, 4, v1
    ds_read_b128 v[176:179], v5
    ds_read_b128 v[180:183], v5 offset:1024
    s_waitcnt lgkmcnt(1)
    buffer_store_dwordx4 v[176:179], v10, s[24:27], s44 offen
    s_mov_b32 exec_hi, 0xffff
    s_waitcnt lgkmcnt(0)
    buffer_store_dwordx4 v[180:183], v10, s[24:27], s44 offen offset:1024
    s_mov_b32 exec_hi, -1
    v_max_f32 v112, abs(v112), abs(v208)
    v_max_f32 v113, abs(v113), abs(v209)
    v_max_f32 v114, abs(v114), abs(v210)
    v_max_f32 v115, abs(v115), abs(v211)
    v_max_f32 v116, abs(v116), abs(v212)
    v_max_f32 v117, abs(v117), abs(v213)
    v_max_f32 v118, abs(v118), abs(v214)
    v_max_f32 v119, abs(v119), abs(v215)
    v_max_f32 v120, abs(v120), abs(v216)
    v_max_f32 v121, abs(v121), abs(v217)
    v_max_f32 v122, abs(v122), abs(v218)
    v_max_f32 v123, abs(v123), abs(v219)
    v_max_f32 v124, abs(v124), abs(v220)
    v_max_f32 v125, abs(v125), abs(v221)
    v_max_f32 v126, abs(v126), abs(v222)
    v_max_f32 v127, abs(v127), abs(v223)
    v_min3_f32 v13, v112, v113, v114
    v_min3_f32 v13, v13, v115, v116
    v_min3_f32 v13, v13, v117, v118
    v_min3_f32 v13, v13, v119, v120
    v_min3_f32 v13, v13, v121, v122
    v_min3_f32 v13, v13, v123, v124
    s_mov_b32 exec_hi, 0
    v_min3_f32 v13, v13, v125, v126
    v_min_f32 v13, v127, v13
    s_mov_b32 exec_hi, -1
    v_cmp_gt_f32 vcc, 0xc800000, v13
    v_mov_b32 v9, 161796
    v_mov_b32 v10, 1
    s_cbranch_vccz L_final
    ds_write_b32 v9, v10
    s_waitcnt lgkmcnt(0)
L_final:
    s_barrier
    ds_read_b32 v9, v9
    s_waitcnt lgkmcnt(0)
    v_readfirstlane_b32 s44, v9
    s_cmp_gt_u32 s44, s53
    s_cbranch_scc1 L_redo
L_end:
    s_endpgm
L_raw:
    s_mov_b32 s50, 1
    buffer_load_dwordx4 v3, s[16:19], s41 offen offset:0 lds
    buffer_load_dwordx4 v3, s[16:19], s41 offen offset:1024 lds
    buffer_load_dwordx4 v3, s[16:19], s41 offen offset:2048 lds
    buffer_load_dwordx4 v3, s[16:19], s41 offen offset:3072 lds
    s_branch L_kdone
L_lump:
    s_mov_b32 s50, 0
    s_waitcnt vmcnt(0)
    s_add_u32 s44, s48, s47
    v_mad_u32_u24 v11, v1, 56, s44
    v_add_u32 v9, s47, v4
    ds_read2_b64 v[192:195], v11 offset0:0 offset1:1
    ds_read2_b64 v[196:199], v11 offset0:2 offset1:3
    ds_read2_b64 v[200:203], v11 offset0:4 offset1:5
    ds_read_b64 v[204:205], v11 offset:48
    s_waitcnt lgkmcnt(0)
    v_mfma_f32_32x32x16_bf16 v[208:223], v[240:243], v[192:195], 0
    v_mfma_f32_32x32x16_bf16 v[208:223], v[244:247], v[196:199], v[208:223]
    v_mfma_f32_32x32x16_bf16 v[224:239], v[240:243], v[200:203], 0
    v_mfma_f32_32x32x16_bf16 v[224:239], v[244:247], v[204:207], v[224:239]
    s_nop 9
    v_pk_mul_f32 v[12:13], v[208:209], v[208:209]
    v_pk_fma_f32 v[12:13], v[210:211], v[210:211], v[12:13]
    v_pk_fma_f32 v[12:13], v[212:213], v[212:213], v[12:13]
    v_pk_fma_f32 v[12:13], v[214:215], v[214:215], v[12:13]
    v_pk_fma_f32 v[12:13], v[216:217], v[216:217], v[12:13]
    v_pk_fma_f32 v[12:13], v[218:219], v[218:219], v[12:13]
    v_pk_fma_f32 v[12:13], v[220:221], v[220:221], v[12:13]
    v_pk_fma_f32 v[12:13], v[222:223], v[222:223], v[12:13]
    v_pk_fma_f32 v[12:13], v[224:225], v[224:225], v[12:13]
    v_pk_fma_f32 v[12:13], v[226:227], v[226:227], v[12:13]
    v_pk_fma_f32 v[12:13], v[228:229], v[228:229], v[12:13]
    v_pk_fma_f32 v[12:13], v[230:231], v[230:231], v[12:13]
    v_pk_fma_f32 v[12:13], v[232:233], v[232:233], v[12:13]
    v_pk_fma_f32 v[12:13], v[234:235], v[234:235], v[12:13]
    v_add_f32 v10, v12, v13
    v_sqrt_f32 v10, v10
    s_nop 0
    v_add_f32 v10, 0x358637bd, v10
    v_rcp_f32 v10, v10
    s_nop 0
    v_pk_mul_f32 v[208:209], v[208:209], v[10:11] op_sel_hi:[1,0]
    v_pk_mul_f32 v[210:211], v[210:211], v[10:11] op_sel_hi:[1,0]
    v_cvt_pk_bf16_f32 v192, v208, v209
    v_pk_mul_f32 v[212:213], v[212:213], v[10:11] op_sel_hi:[1,0]
    v_cvt_pk_bf16_f32 v193, v210, v211
    v_pk_mul_f32 v[214:215], v[214:215], v[10:11] op_sel_hi:[1,0]
    v_cvt_pk_bf16_f32 v194, v212, v213
    v_pk_mul_f32 v[216:217], v[216:217], v[10:11] op_sel_hi:[1,0]
    v_cvt_pk_bf16_f32 v195, v214, 1.0
    v_pk_mul_f32 v[218:219], v[218:219], v[10:11] op_sel_hi:[1,0]
    v_cvt_pk_bf16_f32 v196, v215, v216
    v_pk_mul_f32 v[220:221], v[220:221], v[10:11] op_sel_hi:[1,0]
    ds_write_b128 v9, v[192:195] offset:0
    v_cvt_pk_bf16_f32 v197, v217, v218
    v_pk_mul_f32 v[222:223], v[222:223], v[10:11] op_sel_hi:[1,0]
    v_cvt_pk_bf16_f32 v198, v219, v220
    v_cvt_pk_bf16_f32 v199, v221, s3
    v_pk_mul_f32 v[224:225], v[224:225], v[10:11] op_sel_hi:[1,0]
    v_cvt_pk_bf16_f32 v200, v222, v223
    v_pk_mul_f32 v[226:227], v[226:227], v[10:11] op_sel_hi:[1,0]
    ds_write_b128 v9, v[196:199] offset:512
    v_cvt_pk_bf16_f32 v201, v224, v225
    v_pk_mul_f32 v[228:229], v[228:229], v[10:11] op_sel_hi:[1,0]
    v_cvt_pk_bf16_f32 v202, v226, v227
    v_pk_mul_f32 v[230:231], v[230:231], v[10:11] op_sel_hi:[1,0]
    v_cvt_pk_bf16_f32 v203, v228, 1.0
    v_pk_mul_f32 v[232:233], v[232:233], v[10:11] op_sel_hi:[1,0]
    v_cvt_pk_bf16_f32 v204, v229, v230
    v_pk_mul_f32 v[234:235], v[234:235], v[10:11] op_sel_hi:[1,0]
    ds_write_b128 v9, v[200:203] offset:1024
    v_cvt_pk_bf16_f32 v205, v231, v232
    v_cvt_pk_bf16_f32 v206, v233, v234
    v_cvt_pk_bf16_f32 v207, v235, 1.0
    ds_write_b128 v9, v[204:207] offset:1536
    s_branch L_lumped
L_repoll:
    s_lshl_b32 s44, s36, 4
    v_mov_b32 v11, 0
    v_mov_b32 v15, 0
    s_mov_b64 exec, 1
    buffer_atomic_add v15, v11, s[32:35], s44 offen sc0 sc1
    s_mov_b64 exec, -1
    s_branch L_repolled
L_relay:
    v_mov_b32 v11, 161792
    s_waitcnt vmcnt(0)
    s_mov_b64 exec, 1
    ds_write_b32 v11, v15
    s_mov_b64 exec, -1
    s_branch L_polled
L_redo:
    s_mov_b32 s57, 1
    s_waitcnt vmcnt(0)
    s_barrier
    s_branch L_start
L_slow:
    v_mov_b32 v2, 0xff800000
    v_mov_b32 v7, 0xff800000
    v_mov_b32 v14, 0xff800000
    v_mov_b32 v15, 0xff800000
    s_mov_b32 s56, 0
L_slow_pass:
    s_mov_b32 s41, 0
L_slow_chunk:
    s_waitcnt vmcnt(0) lgkmcnt(0)
    s_barrier
    s_mov_b32 m0, s48
    s_nop 0
    buffer_load_dwordx4 v3, s[16:19], s41 offen offset:0 lds
    buffer_load_dwordx4 v3, s[16:19], s41 offen offset:1024 lds
    buffer_load_dwordx4 v3, s[16:19], s41 offen offset:2048 lds
    buffer_load_dwordx4 v3, s[16:19], s41 offen offset:3072 lds
    s_mov_b32 m0, s42
    s_nop 0
    buffer_load_dwordx4 v3, s[20:23], s41 offen offset:0 lds
    buffer_load_dwordx4 v3, s[20:23], s41 offen offset:1024 lds
    buffer_load_dwordx4 v3, s[20:23], s41 offen offset:2048 lds
    buffer_load_dwordx4 v3, s[20:23], s41 offen offset:3072 lds
    v_mad_u32_u24 v11, v1, 56, s48
    s_waitcnt vmcnt(0)
    ds_read2_b64 v[192:195], v11 offset0:0 offset1:1
    ds_read2_b64 v[196:199], v11 offset0:2 offset1:3
    ds_read2_b64 v[200:203], v11 offset0:4 offset1:5
    ds_read_b64 v[204:205], v11 offset:48
    s_waitcnt lgkmcnt(0)
    v_mfma_f32_32x32x16_bf16 v[208:223], v[240:243], v[192:195], 0
    v_mfma_f32_32x32x16_bf16 v[208:223], v[244:247], v[196:199], v[208:223]
    v_mfma_f32_32x32x16_bf16 v[224:239], v[240:243], v[200:203], 0
    v_mfma_f32_32x32x16_bf16 v[224:239], v[244:247], v[204:207], v[224:239]
    s_nop 9
    v_pk_mul_f32 v[12:13], v[208:209], v[208:209]
    v_pk_fma_f32 v[12:13], v[210:211], v[210:211], v[12:13]
    v_pk_fma_f32 v[12:13], v[212:213], v[212:213], v[12:13]
    v_pk_fma_f32 v[12:13], v[214:215], v[214:215], v[12:13]
    v_pk_fma_f32 v[12:13], v[216:217], v[216:217], v[12:13]
    v_pk_fma_f32 v[12:13], v[218:219], v[218:219], v[12:13]
    v_pk_fma_f32 v[12:13], v[220:221], v[220:221], v[12:13]
    v_pk_fma_f32 v[12:13], v[222:223], v[222:223], v[12:13]
    v_pk_fma_f32 v[12:13], v[224:225], v[224:225], v[12:13]
    v_pk_fma_f32 v[12:13], v[226:227], v[226:227], v[12:13]
    v_pk_fma_f32 v[12:13], v[228:229], v[228:229], v[12:13]
    v_pk_fma_f32 v[12:13], v[230:231], v[230:231], v[12:13]
    v_pk_fma_f32 v[12:13], v[232:233], v[232:233], v[12:13]
    v_pk_fma_f32 v[12:13], v[234:235], v[234:235], v[12:13]
    v_add_f32 v10, v12, v13
    v_sqrt_f32 v10, v10
    s_nop 0
    v_add_f32 v10, 0x358637bd, v10
    v_rcp_f32 v10, v10
    s_nop 0
    v_pk_mul_f32 v[208:209], v[208:209], v[10:11] op_sel_hi:[1,0]
    v_pk_mul_f32 v[210:211], v[210:211], v[10:11] op_sel_hi:[1,0]
    v_cvt_pk_bf16_f32 v192, v208, v209
    v_pk_mul_f32 v[212:213], v[212:213], v[10:11] op_sel_hi:[1,0]
    v_cvt_pk_bf16_f32 v193, v210, v211
    v_pk_mul_f32 v[214:215], v[214:215], v[10:11] op_sel_hi:[1,0]
    v_cvt_pk_bf16_f32 v194, v212, v213
    v_pk_mul_f32 v[216:217], v[216:217], v[10:11] op_sel_hi:[1,0]
    v_cvt_pk_bf16_f32 v195, v214, 1.0
    v_pk_mul_f32 v[218:219], v[218:219], v[10:11] op_sel_hi:[1,0]
    v_cvt_pk_bf16_f32 v196, v215, v216
    v_pk_mul_f32 v[220:221], v[220:221], v[10:11] op_sel_hi:[1,0]
    ds_write_b128 v4, v[192:195] offset:0
    v_cvt_pk_bf16_f32 v197, v217, v218
    v_pk_mul_f32 v[222:223], v[222:223], v[10:11] op_sel_hi:[1,0]
    v_cvt_pk_bf16_f32 v198, v219, v220
    v_cvt_pk_bf16_f32 v199, v221, s3
    v_pk_mul_f32 v[224:225], v[224:225], v[10:11] op_sel_hi:[1,0]
    v_cvt_pk_bf16_f32 v200, v222, v223
    v_pk_mul_f32 v[226:227], v[226:227], v[10:11] op_sel_hi:[1,0]
    ds_write_b128 v4, v[196:199] offset:512
    v_cvt_pk_bf16_f32 v201, v224, v225
    v_pk_mul_f32 v[228:229], v[228:229], v[10:11] op_sel_hi:[1,0]
    v_cvt_pk_bf16_f32 v202, v226, v227
    v_pk_mul_f32 v[230:231], v[230:231], v[10:11] op_sel_hi:[1,0]
    v_cvt_pk_bf16_f32 v203, v228, 1.0
    v_pk_mul_f32 v[232:233], v[232:233], v[10:11] op_sel_hi:[1,0]
    v_cvt_pk_bf16_f32 v204, v229, v230
    v_pk_mul_f32 v[234:235], v[234:235], v[10:11] op_sel_hi:[1,0]
    ds_write_b128 v4, v[200:203] offset:1024
    v_cvt_pk_bf16_f32 v205, v231, v232
    v_cvt_pk_bf16_f32 v206, v233, v234
    v_cvt_pk_bf16_f32 v207, v235, 1.0
    ds_write_b128 v4, v[204:207] offset:1536
    s_waitcnt lgkmcnt(0)
    s_barrier
    ds_read_b128 v[176:179], v5 offset:0
    ds_read_b128 v[180:183], v5 offset:1024
    ds_read_b64_tr_b16 v[184:185], v6 offset:0
    ds_read_b64_tr_b16 v[186:187], v6 offset:224
    ds_read_b64_tr_b16 v[188:189], v6 offset:896
    ds_read_b64_tr_b16 v[190:191], v6 offset:1120
    s_waitcnt lgkmcnt(0)
    s_call_b64 s[58:59], L_slow_tile
    ds_read_b128 v[176:179], v5 offset:2048
    ds_read_b128 v[180:183], v5 offset:3072
    ds_read_b64_tr_b16 v[184:185], v6 offset:1792
    ds_read_b64_tr_b16 v[186:187], v6 offset:2016
    ds_read_b64_tr_b16 v[188:189], v6 offset:2688
    ds_read_b64_tr_b16 v[190:191], v6 offset:2912
    s_waitcnt lgkmcnt(0)
    s_call_b64 s[58:59], L_slow_tile
    ds_read_b128 v[176:179], v5 offset:4096
    ds_read_b128 v[180:183], v5 offset:5120
    ds_read_b64_tr_b16 v[184:185], v6 offset:3584
    ds_read_b64_tr_b16 v[186:187], v6 offset:3808
    ds_read_b64_tr_b16 v[188:189], v6 offset:4480
    ds_read_b64_tr_b16 v[190:191], v6 offset:4704
    s_waitcnt lgkmcnt(0)
    s_call_b64 s[58:59], L_slow_tile
    ds_read_b128 v[176:179], v5 offset:6144
    ds_read_b128 v[180:183], v5 offset:7168
    ds_read_b64_tr_b16 v[184:185], v6 offset:5376
    ds_read_b64_tr_b16 v[186:187], v6 offset:5600
    ds_read_b64_tr_b16 v[188:189], v6 offset:6272
    ds_read_b64_tr_b16 v[190:191], v6 offset:6496
    s_waitcnt lgkmcnt(0)
    s_call_b64 s[58:59], L_slow_tile
    s_add_u32 s41, s41, 28672
    s_cmp_lt_u32 s41, 229376
    s_cbranch_scc1 L_slow_chunk
    s_cmp_eq_u32 s56, 1
    s_cbranch_scc1 L_slow_done
    v_mov_b32 v11, v2
    s_nop 1
    v_permlane32_swap_b32 v11, v2
    s_nop 1
    v_max_f32 v2, v11, v2
    v_mov_b32 v11, v7
    s_nop 1
    v_permlane32_swap_b32 v11, v7
    s_nop 1
    v_max_f32 v7, v11, v7
    v_mov_b32 v11, v14
    s_nop 1
    v_permlane32_swap_b32 v11, v14
    s_nop 1
    v_max_f32 v14, v11, v14
    v_mov_b32 v11, v15
    s_nop 1
    v_permlane32_swap_b32 v11, v15
    s_nop 1
    v_max_f32 v15, v11, v15
    v_mov_b32 v208, v2
    v_mov_b32 v209, v7
    v_mov_b32 v210, v14
    v_mov_b32 v211, v15
    s_barrier
    v_lshlrev_b32 v11, 4, v0
    ds_write_b128 v11, v[208:211]
    s_waitcnt lgkmcnt(0)
    s_barrier
    v_xor_b32 v12, 2048, v11
    ds_read_b128 v[208:211], v12
    s_waitcnt lgkmcnt(0)
    v_max_f32 v2, v2, v208
    v_max_f32 v7, v7, v209
    v_max_f32 v14, v14, v210
    v_max_f32 v15, v15, v211
    v_xor_b32 v12, 4096, v11
    ds_read_b128 v[208:211], v12
    s_waitcnt lgkmcnt(0)
    v_max_f32 v2, v2, v208
    v_max_f32 v7, v7, v209
    v_max_f32 v14, v14, v210
    v_max_f32 v15, v15, v211
    v_xor_b32 v12, 6144, v11
    ds_read_b128 v[208:211], v12
    s_waitcnt lgkmcnt(0)
    v_max_f32 v2, v2, v208
    v_max_f32 v7, v7, v209
    v_max_f32 v14, v14, v210
    v_max_f32 v15, v15, v211
    s_mov_b32 s56, 1
    s_branch L_slow_pass
L_slow_done:
    s_barrier
    s_lshl_b32 s45, s38, 14
    v_lshl_add_u32 v9, v1, 4, s45
    s_nop 11
    ds_write_b128 v9, v[48:51] offset:0
    ds_write_b128 v9, v[52:55] offset:1024
    ds_write_b128 v9, v[56:59] offset:2048
    ds_write_b128 v9, v[60:63] offset:3072
    ds_write_b128 v9, v[64:67] offset:4096
    ds_write_b128 v9, v[68:71] offset:5120
    ds_write_b128 v9, v[72:75] offset:6144
    ds_write_b128 v9, v[76:79] offset:7168
    s_branch L_epi
L_slow_tile:
    v_mfma_f32_32x32x16_bf16 v[112:127], v[176:179], v[16:19], 0
    v_mfma_f32_32x32x16_bf16 v[112:127], v[180:183], v[20:23], v[112:127]
    v_mfma_f32_32x32x16_bf16 v[128:143], v[176:179], v[24:27], 0
    v_mfma_f32_32x32x16_bf16 v[128:143], v[180:183], v[28:31], v[128:143]
    v_mfma_f32_32x32x16_bf16 v[144:159], v[176:179], v[32:35], 0
    v_mfma_f32_32x32x16_bf16 v[144:159], v[180:183], v[36:39], v[144:159]
    v_mfma_f32_32x32x16_bf16 v[160:175], v[176:179], v[40:43], 0
    v_mfma_f32_32x32x16_bf16 v[160:175], v[180:183], v[44:47], v[160:175]
    s_nop 15
    v_mul_f32 v112, s39, v112
    v_mul_f32 v113, s39, v113
    v_mul_f32 v114, s39, v114
    v_mul_f32 v115, s39, v115
    v_mul_f32 v116, s39, v116
    v_mul_f32 v117, s39, v117
    v_mul_f32 v118, s39, v118
    v_mul_f32 v119, s39, v119
    v_mul_f32 v120, s39, v120
    v_mul_f32 v121, s39, v121
    v_mul_f32 v122, s39, v122
    v_mul_f32 v123, s39, v123
    v_mul_f32 v124, s39, v124
    v_mul_f32 v125, s39, v125
    v_mul_f32 v126, s39, v126
    v_mul_f32 v127, s39, v127
    v_mul_f32 v128, s39, v128
    v_mul_f32 v129, s39, v129
    v_mul_f32 v130, s39, v130
    v_mul_f32 v131, s39, v131
    v_mul_f32 v132, s39, v132
    v_mul_f32 v133, s39, v133
    v_mul_f32 v134, s39, v134
    v_mul_f32 v135, s39, v135
    v_mul_f32 v136, s39, v136
    v_mul_f32 v137, s39, v137
    v_mul_f32 v138, s39, v138
    v_mul_f32 v139, s39, v139
    v_mul_f32 v140, s39, v140
    v_mul_f32 v141, s39, v141
    v_mul_f32 v142, s39, v142
    v_mul_f32 v143, s39, v143
    v_mul_f32 v144, s39, v144
    v_mul_f32 v145, s39, v145
    v_mul_f32 v146, s39, v146
    v_mul_f32 v147, s39, v147
    v_mul_f32 v148, s39, v148
    v_mul_f32 v149, s39, v149
    v_mul_f32 v150, s39, v150
    v_mul_f32 v151, s39, v151
    v_mul_f32 v152, s39, v152
    v_mul_f32 v153, s39, v153
    v_mul_f32 v154, s39, v154
    v_mul_f32 v155, s39, v155
    v_mul_f32 v156, s39, v156
    v_mul_f32 v157, s39, v157
    v_mul_f32 v158, s39, v158
    v_mul_f32 v159, s39, v159
    v_mul_f32 v160, s39, v160
    v_mul_f32 v161, s39, v161
    v_mul_f32 v162, s39, v162
    v_mul_f32 v163, s39, v163
    v_mul_f32 v164, s39, v164
    v_mul_f32 v165, s39, v165
    v_mul_f32 v166, s39, v166
    v_mul_f32 v167, s39, v167
    v_mul_f32 v168, s39, v168
    v_mul_f32 v169, s39, v169
    v_mul_f32 v170, s39, v170
    v_mul_f32 v171, s39, v171
    v_mul_f32 v172, s39, v172
    v_mul_f32 v173, s39, v173
    v_mul_f32 v174, s39, v174
    v_mul_f32 v175, s39, v175
    s_cmp_eq_u32 s56, 1
    s_cbranch_scc1 L_slow_exp
    v_max3_f32 v2, v2, v112, v113
    v_max3_f32 v2, v2, v114, v115
    v_max3_f32 v2, v2, v116, v117
    v_max3_f32 v2, v2, v118, v119
    v_max3_f32 v2, v2, v120, v121
    v_max3_f32 v2, v2, v122, v123
    v_max3_f32 v2, v2, v124, v125
    v_max3_f32 v2, v2, v126, v127
    v_max3_f32 v7, v7, v128, v129
    v_max3_f32 v7, v7, v130, v131
    v_max3_f32 v7, v7, v132, v133
    v_max3_f32 v7, v7, v134, v135
    v_max3_f32 v7, v7, v136, v137
    v_max3_f32 v7, v7, v138, v139
    v_max3_f32 v7, v7, v140, v141
    v_max3_f32 v7, v7, v142, v143
    v_max3_f32 v14, v14, v144, v145
    v_max3_f32 v14, v14, v146, v147
    v_max3_f32 v14, v14, v148, v149
    v_max3_f32 v14, v14, v150, v151
    v_max3_f32 v14, v14, v152, v153
    v_max3_f32 v14, v14, v154, v155
    v_max3_f32 v14, v14, v156, v157
    v_max3_f32 v14, v14, v158, v159
    v_max3_f32 v15, v15, v160, v161
    v_max3_f32 v15, v15, v162, v163
    v_max3_f32 v15, v15, v164, v165
    v_max3_f32 v15, v15, v166, v167
    v_max3_f32 v15, v15, v168, v169
    v_max3_f32 v15, v15, v170, v171
    v_max3_f32 v15, v15, v172, v173
    v_max3_f32 v15, v15, v174, v175
    s_setpc_b64 s[58:59]
L_slow_exp:
    v_sub_f32 v112, v112, v2
    v_mul_f32 v112, 0x3fb8aa3b, v112
    v_exp_f32 v112, v112
    v_sub_f32 v113, v113, v2
    v_mul_f32 v113, 0x3fb8aa3b, v113
    v_exp_f32 v113, v113
    v_sub_f32 v114, v114, v2
    v_mul_f32 v114, 0x3fb8aa3b, v114
    v_exp_f32 v114, v114
    v_sub_f32 v115, v115, v2
    v_mul_f32 v115, 0x3fb8aa3b, v115
    v_exp_f32 v115, v115
    v_sub_f32 v116, v116, v2
    v_mul_f32 v116, 0x3fb8aa3b, v116
    v_exp_f32 v116, v116
    v_sub_f32 v117, v117, v2
    v_mul_f32 v117, 0x3fb8aa3b, v117
    v_exp_f32 v117, v117
    v_sub_f32 v118, v118, v2
    v_mul_f32 v118, 0x3fb8aa3b, v118
    v_exp_f32 v118, v118
    v_sub_f32 v119, v119, v2
    v_mul_f32 v119, 0x3fb8aa3b, v119
    v_exp_f32 v119, v119
    v_sub_f32 v120, v120, v2
    v_mul_f32 v120, 0x3fb8aa3b, v120
    v_exp_f32 v120, v120
    v_sub_f32 v121, v121, v2
    v_mul_f32 v121, 0x3fb8aa3b, v121
    v_exp_f32 v121, v121
    v_sub_f32 v122, v122, v2
    v_mul_f32 v122, 0x3fb8aa3b, v122
    v_exp_f32 v122, v122
    v_sub_f32 v123, v123, v2
    v_mul_f32 v123, 0x3fb8aa3b, v123
    v_exp_f32 v123, v123
    v_sub_f32 v124, v124, v2
    v_mul_f32 v124, 0x3fb8aa3b, v124
    v_exp_f32 v124, v124
    v_sub_f32 v125, v125, v2
    v_mul_f32 v125, 0x3fb8aa3b, v125
    v_exp_f32 v125, v125
    v_sub_f32 v126, v126, v2
    v_mul_f32 v126, 0x3fb8aa3b, v126
    v_exp_f32 v126, v126
    v_sub_f32 v127, v127, v2
    v_mul_f32 v127, 0x3fb8aa3b, v127
    v_exp_f32 v127, v127
    v_sub_f32 v128, v128, v7
    v_mul_f32 v128, 0x3fb8aa3b, v128
    v_exp_f32 v128, v128
    v_sub_f32 v129, v129, v7
    v_mul_f32 v129, 0x3fb8aa3b, v129
    v_exp_f32 v129, v129
    v_sub_f32 v130, v130, v7
    v_mul_f32 v130, 0x3fb8aa3b, v130
    v_exp_f32 v130, v130
    v_sub_f32 v131, v131, v7
    v_mul_f32 v131, 0x3fb8aa3b, v131
    v_exp_f32 v131, v131
    v_sub_f32 v132, v132, v7
    v_mul_f32 v132, 0x3fb8aa3b, v132
    v_exp_f32 v132, v132
    v_sub_f32 v133, v133, v7
    v_mul_f32 v133, 0x3fb8aa3b, v133
    v_exp_f32 v133, v133
    v_sub_f32 v134, v134, v7
    v_mul_f32 v134, 0x3fb8aa3b, v134
    v_exp_f32 v134, v134
    v_sub_f32 v135, v135, v7
    v_mul_f32 v135, 0x3fb8aa3b, v135
    v_exp_f32 v135, v135
    v_sub_f32 v136, v136, v7
    v_mul_f32 v136, 0x3fb8aa3b, v136
    v_exp_f32 v136, v136
    v_sub_f32 v137, v137, v7
    v_mul_f32 v137, 0x3fb8aa3b, v137
    v_exp_f32 v137, v137
    v_sub_f32 v138, v138, v7
    v_mul_f32 v138, 0x3fb8aa3b, v138
    v_exp_f32 v138, v138
    v_sub_f32 v139, v139, v7
    v_mul_f32 v139, 0x3fb8aa3b, v139
    v_exp_f32 v139, v139
    v_sub_f32 v140, v140, v7
    v_mul_f32 v140, 0x3fb8aa3b, v140
    v_exp_f32 v140, v140
    v_sub_f32 v141, v141, v7
    v_mul_f32 v141, 0x3fb8aa3b, v141
    v_exp_f32 v141, v141
    v_sub_f32 v142, v142, v7
    v_mul_f32 v142, 0x3fb8aa3b, v142
    v_exp_f32 v142, v142
    v_sub_f32 v143, v143, v7
    v_mul_f32 v143, 0x3fb8aa3b, v143
    v_exp_f32 v143, v143
    v_sub_f32 v144, v144, v14
    v_mul_f32 v144, 0x3fb8aa3b, v144
    v_exp_f32 v144, v144
    v_sub_f32 v145, v145, v14
    v_mul_f32 v145, 0x3fb8aa3b, v145
    v_exp_f32 v145, v145
    v_sub_f32 v146, v146, v14
    v_mul_f32 v146, 0x3fb8aa3b, v146
    v_exp_f32 v146, v146
    v_sub_f32 v147, v147, v14
    v_mul_f32 v147, 0x3fb8aa3b, v147
    v_exp_f32 v147, v147
    v_sub_f32 v148, v148, v14
    v_mul_f32 v148, 0x3fb8aa3b, v148
    v_exp_f32 v148, v148
    v_sub_f32 v149, v149, v14
    v_mul_f32 v149, 0x3fb8aa3b, v149
    v_exp_f32 v149, v149
    v_sub_f32 v150, v150, v14
    v_mul_f32 v150, 0x3fb8aa3b, v150
    v_exp_f32 v150, v150
    v_sub_f32 v151, v151, v14
    v_mul_f32 v151, 0x3fb8aa3b, v151
    v_exp_f32 v151, v151
    v_sub_f32 v152, v152, v14
    v_mul_f32 v152, 0x3fb8aa3b, v152
    v_exp_f32 v152, v152
    v_sub_f32 v153, v153, v14
    v_mul_f32 v153, 0x3fb8aa3b, v153
    v_exp_f32 v153, v153
    v_sub_f32 v154, v154, v14
    v_mul_f32 v154, 0x3fb8aa3b, v154
    v_exp_f32 v154, v154
    v_sub_f32 v155, v155, v14
    v_mul_f32 v155, 0x3fb8aa3b, v155
    v_exp_f32 v155, v155
    v_sub_f32 v156, v156, v14
    v_mul_f32 v156, 0x3fb8aa3b, v156
    v_exp_f32 v156, v156
    v_sub_f32 v157, v157, v14
    v_mul_f32 v157, 0x3fb8aa3b, v157
    v_exp_f32 v157, v157
    v_sub_f32 v158, v158, v14
    v_mul_f32 v158, 0x3fb8aa3b, v158
    v_exp_f32 v158, v158
    v_sub_f32 v159, v159, v14
    v_mul_f32 v159, 0x3fb8aa3b, v159
    v_exp_f32 v159, v159
    v_sub_f32 v160, v160, v15
    v_mul_f32 v160, 0x3fb8aa3b, v160
    v_exp_f32 v160, v160
    v_sub_f32 v161, v161, v15
    v_mul_f32 v161, 0x3fb8aa3b, v161
    v_exp_f32 v161, v161
    v_sub_f32 v162, v162, v15
    v_mul_f32 v162, 0x3fb8aa3b, v162
    v_exp_f32 v162, v162
    v_sub_f32 v163, v163, v15
    v_mul_f32 v163, 0x3fb8aa3b, v163
    v_exp_f32 v163, v163
    v_sub_f32 v164, v164, v15
    v_mul_f32 v164, 0x3fb8aa3b, v164
    v_exp_f32 v164, v164
    v_sub_f32 v165, v165, v15
    v_mul_f32 v165, 0x3fb8aa3b, v165
    v_exp_f32 v165, v165
    v_sub_f32 v166, v166, v15
    v_mul_f32 v166, 0x3fb8aa3b, v166
    v_exp_f32 v166, v166
    v_sub_f32 v167, v167, v15
    v_mul_f32 v167, 0x3fb8aa3b, v167
    v_exp_f32 v167, v167
    v_sub_f32 v168, v168, v15
    v_mul_f32 v168, 0x3fb8aa3b, v168
    v_exp_f32 v168, v168
    v_sub_f32 v169, v169, v15
    v_mul_f32 v169, 0x3fb8aa3b, v169
    v_exp_f32 v169, v169
    v_sub_f32 v170, v170, v15
    v_mul_f32 v170, 0x3fb8aa3b, v170
    v_exp_f32 v170, v170
    v_sub_f32 v171, v171, v15
    v_mul_f32 v171, 0x3fb8aa3b, v171
    v_exp_f32 v171, v171
    v_sub_f32 v172, v172, v15
    v_mul_f32 v172, 0x3fb8aa3b, v172
    v_exp_f32 v172, v172
    v_sub_f32 v173, v173, v15
    v_mul_f32 v173, 0x3fb8aa3b, v173
    v_exp_f32 v173, v173
    v_sub_f32 v174, v174, v15
    v_mul_f32 v174, 0x3fb8aa3b, v174
    v_exp_f32 v174, v174
    v_sub_f32 v175, v175, v15
    v_mul_f32 v175, 0x3fb8aa3b, v175
    v_exp_f32 v175, v175
    s_nop 1
    v_smfmac_f32_32x32x32_bf16 v[48:63], v[184:187], v[112:119], v8
    v_smfmac_f32_32x32x32_bf16 v[48:63], v[188:191], v[120:127], v8
    v_smfmac_f32_32x32x32_bf16 v[64:79], v[184:187], v[128:135], v8
    v_smfmac_f32_32x32x32_bf16 v[64:79], v[188:191], v[136:143], v8
    v_smfmac_f32_32x32x32_bf16 v[80:95], v[184:187], v[144:151], v8
    v_smfmac_f32_32x32x32_bf16 v[80:95], v[188:191], v[152:159], v8
    v_smfmac_f32_32x32x32_bf16 v[96:111], v[184:187], v[160:167], v8
    v_smfmac_f32_32x32x32_bf16 v[96:111], v[188:191], v[168:175], v8
    s_setpc_b64 s[58:59]
.section .rodata,"a"
.p2align 6
.amdhsa_kernel standalone__qk_norm__prompt_kernel
  .amdhsa_next_free_vgpr 248
  .amdhsa_next_free_sgpr 80
  .amdhsa_accum_offset 248
  .amdhsa_group_segment_fixed_size 0
  .amdhsa_kernarg_size 56
  .amdhsa_user_sgpr_count 2
  .amdhsa_user_sgpr_kernarg_segment_ptr 1
  .amdhsa_system_sgpr_workgroup_id_x 1
  .amdhsa_float_denorm_mode_32 3
.end_amdhsa_kernel
```
